```python
import torch

def _softmax(x, axis=-1):
    return torch.softmax(x, dim=axis)
def _gelu(x):
    return torch.nn.functional.gelu(x, approximate="tanh")
def _silu(x):
    return torch.nn.functional.silu(x)
def _sigmoid(x):
    return torch.sigmoid(x)
def _layernorm(x, axis=-1, eps=1e-5):
    m = x.mean(dim=axis, keepdim=True)
    v = x.var(dim=axis, keepdim=True, unbiased=False)
    return (x - m) / torch.sqrt(v + eps)
def _scatter_add(tgt, idx, src, axis=0):
    return tgt.clone().index_add_(axis, idx, src)
def _segment_sum(src, seg, n):
    out = torch.zeros((n,) + src.shape[1:], dtype=src.dtype)
    return out.index_add_(0, seg, src)
def _pad(x, pw):
    flat = tuple(v for pair in reversed(pw) for v in pair)
    return torch.nn.functional.pad(x, flat)

kernel_name = 'concat_heads__sliding_block_cached__mha_block_cached__decode'

def setup_inputs():

    _w = (lambda a: (lambda t: t.to(torch.bfloat16) if t.is_floating_point() else t)(torch.as_tensor(a)))
    def _A_setup():
        B, Sq, D = 1, 1, 512
        Hq, Hkv, Sk, Dh = 32, 8, 16384, 128
        assert Hq % Hkv == 0, (Hq, Hkv)
        return {
            "x": _w((lambda *s: torch.randn(*s, dtype=torch.bfloat16) * 0.8)(B, Sq, D)),
            "k_cache": _w((lambda *s: torch.randn(*s, dtype=torch.bfloat16) * 1.6)(B, Hkv, Sk, Dh)),
            "v_cache": _w((lambda *s: torch.randn(*s, dtype=torch.bfloat16) * 0.2)(B, Hkv, Sk, Dh)),
            "wq": _w((lambda *s: torch.randn(*s, dtype=torch.bfloat16) * 1.6)(D, Hq * Dh) * (D ** -0.5)),
            "wo": _w((lambda *s: torch.randn(*s, dtype=torch.bfloat16) * 0.2)(Hq * Dh, D) * ((Hq * Dh) ** -0.5)),
        }
    _A_in = _A_setup()

    def _B_setup():
        B, Sq, D = 1, 1, 512
        H, Sk, Dh = 32, 16384, 128
        return {
            "x": _w((lambda *s: torch.randn(*s, dtype=torch.bfloat16) * 0.8)(B, Sq, D)),
            "k_cache": _w((lambda *s: torch.randn(*s, dtype=torch.bfloat16) * 1.6)(B, H, Sk, Dh)),
            "v_cache": _w((lambda *s: torch.randn(*s, dtype=torch.bfloat16) * 0.2)(B, H, Sk, Dh)),
            "wq": _w((lambda *s: torch.randn(*s, dtype=torch.bfloat16) * 1.6)(D, H * Dh) * (D ** -0.5)),
            "wo": _w((lambda *s: torch.randn(*s, dtype=torch.bfloat16) * 0.2)(H * Dh, D) * ((H * Dh) ** -0.5)),
        }
    _B_in = _B_setup()

    return {
        "A_x": _A_in["x"],
        "A_k_cache": _A_in["k_cache"],
        "A_v_cache": _A_in["v_cache"],
        "A_wq": _A_in["wq"],
        "A_wo": _A_in["wo"],
        "B_x": _B_in["x"],
        "B_k_cache": _B_in["k_cache"],
        "B_v_cache": _B_in["v_cache"],
        "B_wq": _B_in["wq"],
        "B_wo": _B_in["wo"],
    }

def reference(A_x, A_k_cache, A_v_cache, A_wq, A_wo, B_x, B_k_cache, B_v_cache, B_wq, B_wo):
    def _A_ref(x, k_cache, v_cache, wq, wo):
        B, Sq, D = x.shape
        Hq, Dh = 32, 128
        Hkv, Sk = k_cache.shape[1], k_cache.shape[2]
        W = min(4096, max(256, Sk // 4))
        rep = Hq // Hkv
        q = (lambda x, *d: x.permute(*d))((x @ wq).reshape(B, Sq, Hq, Dh), 0, 2, 1, 3)
        k = (lambda x, n, axis: torch.repeat_interleave(x, n, dim=axis))(k_cache[:, :, Sk - W:, :], rep, axis=1)
        v = (lambda x, n, axis: torch.repeat_interleave(x, n, dim=axis))(v_cache[:, :, Sk - W:, :], rep, axis=1)
        scores = torch.einsum("bhqd,bhkd->bhqk", q, k) * (Dh ** -0.5)
        p = _softmax(scores, axis=-1)
        o = torch.einsum("bhqk,bhkd->bhqd", p, v)
        return (lambda x, *d: x.permute(*d))(o, 0, 2, 1, 3).reshape(B, Sq, Hq * Dh) @ wo

    def _B_ref(x, k_cache, v_cache, wq, wo):
        B, Sq, D = x.shape
        H, Dh = 32, 128
        q = (lambda x, *d: x.permute(*d))((x @ wq).reshape(B, Sq, H, Dh), 0, 2, 1, 3)
        scores = torch.einsum("bhqd,bhkd->bhqk", q, k_cache) * (Dh ** -0.5)
        p = _softmax(scores, axis=-1)
        o = torch.einsum("bhqk,bhkd->bhqd", p, v_cache)
        return (lambda x, *d: x.permute(*d))(o, 0, 2, 1, 3).reshape(B, Sq, H * Dh) @ wo

    a = _A_ref(A_x, A_k_cache, A_v_cache, A_wq, A_wo)
    b = _B_ref(B_x, B_k_cache, B_v_cache, B_wq, B_wo)
    return torch.concatenate([a, b], axis=-1)
```

```asm
; @launch kernel=attn_main_kernel grid=(256,1,1) block=(512,1,1) lds=53248
; @launch kernel=attn_final_kernel grid=(64,1,1) block=(256,1,1) lds=2048
.amdgcn_target "amdgcn-amd-amdhsa--gfx950"
.text
.globl attn_main_kernel
.p2align 8
.type attn_main_kernel,@function
attn_main_kernel:
    s_cmp_ge_u32 s2, 0x100
    s_cbranch_scc1 L_main_end
    s_load_dwordx16 s[16:31], s[0:1], 0
    s_load_dwordx8 s[32:39], s[0:1], 64
    s_load_dwordx2 s[40:41], s[0:1], 96
    s_and_b32 s5, s2, 7
    s_lshr_b32 s7, s2, 3
    s_and_b32 s7, s7, 3
    s_lshr_b32 s4, s2, 5
    s_lshl_b32 s3, s5, 2
    s_add_u32 s3, s3, s7
    s_lshl_b32 s9, s3, 3
    s_add_u32 s9, s9, s4
    s_mov_b32 s8, 0x3e0293ee
    v_lshrrev_b32 v52, 6, v0
    v_and_b32 v53, 63, v0
    v_bfe_u32 v54, v0, 4, 2
    v_and_b32 v55, 15, v0
    v_readfirstlane_b32 s13, v52
    v_lshlrev_b32 v1, 12, v52
    v_lshl_add_u32 v1, v53, 4, v1
    v_lshlrev_b32 v3, 4, v52
    v_lshl_add_u32 v3, v54, 2, v3
    v_lshlrev_b32 v2, 13, v3
    v_lshl_add_u32 v2, v55, 4, v2
    v_lshlrev_b32 v3, 1, v3
    v_lshlrev_b32 v60, 9, v52
    v_lshl_add_u32 v60, v55, 5, v60
    v_lshl_add_u32 v60, v54, 3, v60
    v_lshlrev_b32 v6, 4, v55
    v_mov_b32 v4, 0
    v_mov_b32 v5, 1
    v_mov_b32 v7, 0
    v_lshlrev_b32 v56, 2, v55
    ds_write_b32 v56, v4 offset:16640
    s_memrealtime s[98:99]
    s_lshr_b32 s6, s13, 2
    s_lshl_b32 s6, s6, 4
    s_lshl_b32 s14, s3, 22
    s_lshl_b32 s15, s4, 19
    s_add_u32 s14, s14, s15
    s_waitcnt lgkmcnt(0)
    s_mov_b32 s60, s38
    s_mov_b32 s61, s39
    s_mov_b32 s62, 256
    s_mov_b32 s63, 0x00020000
    s_lshr_b32 s39, s4, 2
    s_and_b32 s37, s4, 3
    s_cmp_eq_u32 s39, 0
    s_cselect_b64 s[68:69], s[22:23], s[32:33]
    s_mov_b32 s70, 0x400000
    s_mov_b32 s71, 0x00020000
    s_cselect_b64 s[72:73], s[16:17], s[26:27]
    s_mov_b32 s74, 1024
    s_mov_b32 s75, 0x00020000
    s_lshl_b32 s7, s37, 8
    buffer_load_dwordx2 v[58:59], v3, s[72:75], s7 offen
    s_lshl_b32 s7, s37, 20
    s_lshl_b32 s15, s3, 8
    s_add_u32 s7, s7, s15
    buffer_load_dwordx4 v[8:11], v2, s[68:71], s7 offen
    s_add_u32 s7, s7, 0x2000
    buffer_load_dwordx4 v[12:15], v2, s[68:71], s7 offen
    s_add_u32 s7, s7, 0x2000
    buffer_load_dwordx4 v[16:19], v2, s[68:71], s7 offen
    s_add_u32 s7, s7, 0x2000
    buffer_load_dwordx4 v[20:23], v2, s[68:71], s7 offen
    s_cmp_lg_u32 s13, 0
    s_cbranch_scc1 L_nonon
    s_or_b32 s98, s98, 1
    v_mov_b32 v128, s98
    v_mov_b32 v129, s99
    v_mov_b32 v130, 0
    v_mov_b32 v131, 0
    s_lshl_b32 s7, s3, 3
    s_mov_b64 exec, 1
    buffer_atomic_cmpswap_x2 v[128:131], v4, s[60:63], s7 offen sc0 sc1
    s_mov_b64 exec, -1
L_nonon:
    s_add_u32 s44, s28, s14
    s_addc_u32 s45, s29, 0
    s_mov_b32 s46, 524288
    s_mov_b32 s47, 0x00020000
    s_add_u32 s48, s30, s14
    s_addc_u32 s49, s31, 0
    s_mov_b32 s50, 524288
    s_mov_b32 s51, 0x00020000
    s_mov_b32 s76, s40
    s_mov_b32 s77, s41
    s_mov_b32 s78, 16777216
    s_mov_b32 s79, 0x00020000
    s_lshl_b32 s14, s5, 22
    s_lshl_b32 s15, s4, 17
    s_add_u32 s14, s14, s15
    s_add_u32 s14, s14, 3145728
    s_add_u32 s52, s18, s14
    s_addc_u32 s53, s19, 0
    s_mov_b32 s54, 131072
    s_mov_b32 s55, 0x00020000
    s_add_u32 s56, s20, s14
    s_addc_u32 s57, s21, 0
    s_mov_b32 s58, 131072
    s_mov_b32 s59, 0x00020000
    s_barrier
    s_cmp_eq_u32 s13, 0
    s_cbranch_scc1 L_nopf
    s_call_b64 s[36:37], L_PF0
    s_waitcnt vmcnt(8)
    s_branch L_pfj
L_nopf:
    s_setprio 3
    s_waitcnt vmcnt(1)
L_pfj:
    v_and_b32 v52, 0xffff, v58
    v_lshlrev_b32 v53, 16, v58
    v_lshrrev_b32 v54, 16, v58
    v_and_b32 v55, 0xffff0000, v58
    v_dot2_f32_bf16 v44, v8, v52, 0
    v_dot2_f32_bf16 v45, v8, v53, 0
    v_dot2_f32_bf16 v46, v9, v52, 0
    v_dot2_f32_bf16 v47, v9, v53, 0
    v_dot2_f32_bf16 v48, v10, v52, 0
    v_dot2_f32_bf16 v49, v10, v53, 0
    v_dot2_f32_bf16 v50, v11, v52, 0
    v_dot2_f32_bf16 v51, v11, v53, 0
    v_dot2c_f32_bf16 v44, v12, v54
    v_dot2c_f32_bf16 v45, v12, v55
    v_dot2c_f32_bf16 v46, v13, v54
    v_dot2c_f32_bf16 v47, v13, v55
    v_dot2c_f32_bf16 v48, v14, v54
    v_dot2c_f32_bf16 v49, v14, v55
    v_dot2c_f32_bf16 v50, v15, v54
    v_dot2c_f32_bf16 v51, v15, v55
    v_and_b32 v52, 0xffff, v59
    v_lshlrev_b32 v53, 16, v59
    v_lshrrev_b32 v54, 16, v59
    v_and_b32 v55, 0xffff0000, v59
    v_dot2c_f32_bf16 v44, v16, v52
    v_dot2c_f32_bf16 v45, v16, v53
    v_dot2c_f32_bf16 v46, v17, v52
    v_dot2c_f32_bf16 v47, v17, v53
    v_dot2c_f32_bf16 v48, v18, v52
    v_dot2c_f32_bf16 v49, v18, v53
    v_dot2c_f32_bf16 v50, v19, v52
    v_dot2c_f32_bf16 v51, v19, v53
    v_dot2c_f32_bf16 v44, v20, v54
    v_dot2c_f32_bf16 v45, v20, v55
    v_dot2c_f32_bf16 v46, v21, v54
    v_dot2c_f32_bf16 v47, v21, v55
    v_dot2c_f32_bf16 v48, v22, v54
    v_dot2c_f32_bf16 v49, v22, v55
    v_dot2c_f32_bf16 v50, v23, v54
    v_dot2c_f32_bf16 v51, v23, v55
    s_nop 3
    s_nop 1
    v_permlane32_swap_b32 v44, v48
    v_permlane32_swap_b32 v45, v49
    v_permlane32_swap_b32 v46, v50
    v_permlane32_swap_b32 v47, v51
    s_nop 1
    v_add_f32 v44, v44, v48
    v_add_f32 v45, v45, v49
    v_add_f32 v46, v46, v50
    v_add_f32 v47, v47, v51
    s_nop 1
    v_permlane16_swap_b32 v44, v46
    v_permlane16_swap_b32 v45, v47
    s_nop 1
    v_add_f32 v44, v44, v46
    v_add_f32 v45, v45, v47
    ds_write_b64 v60, v[44:45] offset:20480
    s_waitcnt lgkmcnt(0)
    s_barrier
    s_cmp_lg_u32 s13, 0
    s_cbranch_scc1 L_qwait
    v_lshlrev_b32 v56, 3, v0
    ds_read_b64 v[136:137], v56 offset:20480
    ds_read_b64 v[138:139], v56 offset:20992
    ds_read_b64 v[140:141], v56 offset:21504
    ds_read_b64 v[142:143], v56 offset:22016
    ds_read_b64 v[144:145], v56 offset:22528
    ds_read_b64 v[146:147], v56 offset:23040
    ds_read_b64 v[148:149], v56 offset:23552
    ds_read_b64 v[150:151], v56 offset:24064
    v_lshlrev_b32 v57, 4, v0
    s_lshl_b32 s15, s3, 13
    s_add_u32 s15, s15, 2097152
    s_lshl_b32 s7, s4, 10
    s_add_u32 s7, s7, s15
    s_waitcnt vmcnt(0) lgkmcnt(0)
    v_readfirstlane_b32 s14, v128
    v_readfirstlane_b32 s37, v129
    v_add_f32 v136, v136, v144
    v_add_f32 v137, v137, v145
    v_add_f32 v138, v138, v146
    v_add_f32 v139, v139, v147
    v_add_f32 v140, v140, v148
    v_add_f32 v141, v141, v149
    v_add_f32 v142, v142, v150
    v_add_f32 v143, v143, v151
    v_add_f32 v136, v136, v140
    v_add_f32 v137, v137, v141
    v_add_f32 v138, v138, v142
    v_add_f32 v139, v139, v143
    v_add_f32 v136, v136, v138
    v_add_f32 v137, v137, v139
    s_cmp_eq_u32 s14, 0
    s_cselect_b32 s98, s98, s14
    s_cselect_b32 s99, s99, s37
    v_mov_b32 v138, s98
    v_mov_b32 v139, s99
    buffer_store_dwordx4 v[136:139], v57, s[76:79], s7 offen sc0 sc1
    s_mov_b32 s14, 40000
    s_add_u32 s7, s15, 0x1000
L_poll:
    buffer_load_dwordx4 v[144:147], v57, s[76:79], s15 offen offset:0 sc0 sc1
    buffer_load_dwordx4 v[148:151], v57, s[76:79], s15 offen offset:1024 sc0 sc1
    buffer_load_dwordx4 v[152:155], v57, s[76:79], s15 offen offset:2048 sc0 sc1
    buffer_load_dwordx4 v[156:159], v57, s[76:79], s15 offen offset:3072 sc0 sc1
    buffer_load_dwordx4 v[160:163], v57, s[76:79], s7 offen offset:0 sc0 sc1
    buffer_load_dwordx4 v[164:167], v57, s[76:79], s7 offen offset:1024 sc0 sc1
    buffer_load_dwordx4 v[168:171], v57, s[76:79], s7 offen offset:2048 sc0 sc1
    buffer_load_dwordx4 v[172:175], v57, s[76:79], s7 offen offset:3072 sc0 sc1
    s_waitcnt vmcnt(0)
    v_cmp_ne_u64 vcc, s[98:99], v[146:147]
    v_cmp_ne_u64 s[100:101], s[98:99], v[150:151]
    s_or_b64 vcc, vcc, s[100:101]
    v_cmp_ne_u64 s[100:101], s[98:99], v[154:155]
    s_or_b64 vcc, vcc, s[100:101]
    v_cmp_ne_u64 s[100:101], s[98:99], v[158:159]
    s_or_b64 vcc, vcc, s[100:101]
    v_cmp_ne_u64 s[100:101], s[98:99], v[162:163]
    s_or_b64 vcc, vcc, s[100:101]
    v_cmp_ne_u64 s[100:101], s[98:99], v[166:167]
    s_or_b64 vcc, vcc, s[100:101]
    v_cmp_ne_u64 s[100:101], s[98:99], v[170:171]
    s_or_b64 vcc, vcc, s[100:101]
    v_cmp_ne_u64 s[100:101], s[98:99], v[174:175]
    s_or_b64 vcc, vcc, s[100:101]
    s_cmp_eq_u64 vcc, 0
    s_cbranch_scc1 L_gather
    s_sub_u32 s14, s14, 1
    s_cmp_lg_u32 s14, 0
    s_cbranch_scc1 L_poll
    s_branch L_fallback
L_gather:
    v_lshlrev_b32 v54, 2, v0
    v_add_f32 v144, v144, v148
    v_add_f32 v152, v152, v156
    v_add_f32 v145, v145, v149
    v_add_f32 v153, v153, v157
    v_add_f32 v144, v144, v152
    v_add_f32 v145, v145, v153
    v_cvt_pk_bf16_f32 v144, v144, v145
    ds_write_b32 v54, v144 offset:0
    v_add_f32 v160, v160, v164
    v_add_f32 v168, v168, v172
    v_add_f32 v161, v161, v165
    v_add_f32 v169, v169, v173
    v_add_f32 v160, v160, v168
    v_add_f32 v161, v161, v169
    v_cvt_pk_bf16_f32 v160, v160, v161
    ds_write_b32 v54, v160 offset:256
L_qdone:
    s_waitcnt lgkmcnt(0)
    s_barrier
    s_setprio 0
    s_call_b64 s[36:37], L_PF0
    s_call_b64 s[36:37], L_PF1
    s_branch L_qread
L_qwait:
    s_call_b64 s[36:37], L_PF1
    s_barrier
L_qread:
    ds_read_b128 v[22:25], v6 offset:0
    ds_read_b128 v[8:11], v6 offset:256
    v_mov_b32 v20, 0xff800000
    v_mov_b32 v21, 0
    v_mov_b32 v12, 0
    v_mov_b32 v13, 0
    v_mov_b32 v14, 0
    v_mov_b32 v15, 0
    v_mov_b32 v16, 0
    v_mov_b32 v17, 0
    v_mov_b32 v18, 0
    v_mov_b32 v19, 0
    v_mov_b32 v34, 0xff800000
    v_mov_b32 v35, 0
    v_mov_b32 v26, 0
    v_mov_b32 v27, 0
    v_mov_b32 v28, 0
    v_mov_b32 v29, 0
    v_mov_b32 v30, 0
    v_mov_b32 v31, 0
    v_mov_b32 v32, 0
    v_mov_b32 v33, 0
    s_cmp_lg_u32 s6, 0
    s_cbranch_scc1 L_pe1
    s_mov_b64 s[60:61], s[52:53]
    s_mov_b64 s[62:63], s[54:55]
    s_mov_b64 s[64:65], s[56:57]
    s_mov_b64 s[66:67], s[58:59]
    s_mov_b32 s10, 65536
    s_mov_b32 s11, 0
    s_branch L_pe2
L_pe1:
    s_mov_b64 s[60:61], s[52:53]
    s_mov_b64 s[62:63], s[54:55]
    s_mov_b64 s[64:65], s[56:57]
    s_mov_b64 s[66:67], s[58:59]
    s_mov_b32 s10, 65536
    s_mov_b32 s11, 0
L_pe2:
    s_waitcnt lgkmcnt(0)
    s_waitcnt vmcnt(12)
    v_dot2_f32_bf16 v44, v64, v8, 0
    v_dot2_f32_bf16 v45, v68, v8, 0
    v_dot2_f32_bf16 v46, v72, v8, 0
    v_dot2_f32_bf16 v47, v76, v8, 0
    v_dot2c_f32_bf16 v44, v65, v9
    v_dot2c_f32_bf16 v45, v69, v9
    v_dot2c_f32_bf16 v46, v73, v9
    v_dot2c_f32_bf16 v47, v77, v9
    v_dot2c_f32_bf16 v44, v66, v10
    v_dot2c_f32_bf16 v45, v70, v10
    v_dot2c_f32_bf16 v46, v74, v10
    v_dot2c_f32_bf16 v47, v78, v10
    v_dot2c_f32_bf16 v44, v67, v11
    v_dot2c_f32_bf16 v45, v71, v11
    v_dot2c_f32_bf16 v46, v75, v11
    v_dot2c_f32_bf16 v47, v79, v11
    buffer_load_dwordx4 v[64:67], v1, s[44:47], s10 offen offset:0 nt
    buffer_load_dwordx4 v[68:71], v1, s[44:47], s10 offen offset:1024 nt
    buffer_load_dwordx4 v[72:75], v1, s[44:47], s10 offen offset:2048 nt
    buffer_load_dwordx4 v[76:79], v1, s[44:47], s10 offen offset:3072 nt
    v_add_f32_dpp v44, v44, v44 row_ror:8 row_mask:0xf bank_mask:0xf
    v_add_f32_dpp v45, v45, v45 row_ror:8 row_mask:0xf bank_mask:0xf
    v_add_f32_dpp v46, v46, v46 row_ror:8 row_mask:0xf bank_mask:0xf
    v_add_f32_dpp v47, v47, v47 row_ror:8 row_mask:0xf bank_mask:0xf
    v_add_f32_dpp v44, v44, v44 row_ror:4 row_mask:0xf bank_mask:0xf
    v_add_f32_dpp v45, v45, v45 row_ror:4 row_mask:0xf bank_mask:0xf
    v_add_f32_dpp v46, v46, v46 row_ror:4 row_mask:0xf bank_mask:0xf
    v_add_f32_dpp v47, v47, v47 row_ror:4 row_mask:0xf bank_mask:0xf
    v_add_f32_dpp v44, v44, v44 row_ror:2 row_mask:0xf bank_mask:0xf
    v_add_f32_dpp v45, v45, v45 row_ror:2 row_mask:0xf bank_mask:0xf
    v_add_f32_dpp v46, v46, v46 row_ror:2 row_mask:0xf bank_mask:0xf
    v_add_f32_dpp v47, v47, v47 row_ror:2 row_mask:0xf bank_mask:0xf
    v_add_f32_dpp v44, v44, v44 row_ror:1 row_mask:0xf bank_mask:0xf
    v_add_f32_dpp v45, v45, v45 row_ror:1 row_mask:0xf bank_mask:0xf
    v_add_f32_dpp v46, v46, v46 row_ror:1 row_mask:0xf bank_mask:0xf
    v_add_f32_dpp v47, v47, v47 row_ror:1 row_mask:0xf bank_mask:0xf
    v_max3_f32 v52, v44, v45, v20
    v_max3_f32 v52, v52, v46, v47
    v_mul_f32 v53, s8, v52
    v_fma_f32 v54, v20, s8, -v53
    v_fma_f32 v44, v44, s8, -v53
    v_fma_f32 v45, v45, s8, -v53
    v_fma_f32 v46, v46, s8, -v53
    v_fma_f32 v47, v47, s8, -v53
    v_exp_f32 v54, v54
    v_exp_f32 v44, v44
    v_exp_f32 v45, v45
    v_exp_f32 v46, v46
    v_exp_f32 v47, v47
    v_mov_b32 v20, v52
    v_fma_f32 v21, v21, v54, v44
    v_mul_f32 v12, v12, v54
    v_mul_f32 v13, v13, v54
    v_mul_f32 v14, v14, v54
    v_mul_f32 v15, v15, v54
    v_mul_f32 v16, v16, v54
    v_mul_f32 v17, v17, v54
    v_mul_f32 v18, v18, v54
    v_mul_f32 v19, v19, v54
    v_add_f32 v21, v21, v45
    v_add_f32 v21, v21, v46
    v_add_f32 v21, v21, v47
    v_cvt_pk_bf16_f32 v48, v44, 0
    v_cvt_pk_bf16_f32 v49, v45, 0
    v_cvt_pk_bf16_f32 v50, v46, 0
    v_cvt_pk_bf16_f32 v51, v47, 0
    v_lshlrev_b32 v44, 16, v48
    v_lshlrev_b32 v45, 16, v49
    v_lshlrev_b32 v46, 16, v50
    v_lshlrev_b32 v47, 16, v51
    s_waitcnt vmcnt(12)
    v_dot2c_f32_bf16 v12, v80, v48
    v_dot2c_f32_bf16 v13, v80, v44
    v_dot2c_f32_bf16 v14, v81, v48
    v_dot2c_f32_bf16 v15, v81, v44
    v_dot2c_f32_bf16 v16, v82, v48
    v_dot2c_f32_bf16 v17, v82, v44
    v_dot2c_f32_bf16 v18, v83, v48
    v_dot2c_f32_bf16 v19, v83, v44
    v_dot2c_f32_bf16 v12, v84, v49
    v_dot2c_f32_bf16 v13, v84, v45
    v_dot2c_f32_bf16 v14, v85, v49
    v_dot2c_f32_bf16 v15, v85, v45
    v_dot2c_f32_bf16 v16, v86, v49
    v_dot2c_f32_bf16 v17, v86, v45
    v_dot2c_f32_bf16 v18, v87, v49
    v_dot2c_f32_bf16 v19, v87, v45
    v_dot2c_f32_bf16 v12, v88, v50
    v_dot2c_f32_bf16 v13, v88, v46
    v_dot2c_f32_bf16 v14, v89, v50
    v_dot2c_f32_bf16 v15, v89, v46
    v_dot2c_f32_bf16 v16, v90, v50
    v_dot2c_f32_bf16 v17, v90, v46
    v_dot2c_f32_bf16 v18, v91, v50
    v_dot2c_f32_bf16 v19, v91, v46
    v_dot2c_f32_bf16 v12, v92, v51
    v_dot2c_f32_bf16 v13, v92, v47
    v_dot2c_f32_bf16 v14, v93, v51
    v_dot2c_f32_bf16 v15, v93, v47
    v_dot2c_f32_bf16 v16, v94, v51
    v_dot2c_f32_bf16 v17, v94, v47
    v_dot2c_f32_bf16 v18, v95, v51
    v_dot2c_f32_bf16 v19, v95, v47
    buffer_load_dwordx4 v[80:83], v1, s[48:51], s10 offen offset:0 nt
    buffer_load_dwordx4 v[84:87], v1, s[48:51], s10 offen offset:1024 nt
    buffer_load_dwordx4 v[88:91], v1, s[48:51], s10 offen offset:2048 nt
    buffer_load_dwordx4 v[92:95], v1, s[48:51], s10 offen offset:3072 nt
    s_waitcnt vmcnt(12)
    v_dot2_f32_bf16 v44, v96, v8, 0
    v_dot2_f32_bf16 v45, v100, v8, 0
    v_dot2_f32_bf16 v46, v104, v8, 0
    v_dot2_f32_bf16 v47, v108, v8, 0
    v_dot2c_f32_bf16 v44, v97, v9
    v_dot2c_f32_bf16 v45, v101, v9
    v_dot2c_f32_bf16 v46, v105, v9
    v_dot2c_f32_bf16 v47, v109, v9
    v_dot2c_f32_bf16 v44, v98, v10
    v_dot2c_f32_bf16 v45, v102, v10
    v_dot2c_f32_bf16 v46, v106, v10
    v_dot2c_f32_bf16 v47, v110, v10
    v_dot2c_f32_bf16 v44, v99, v11
    v_dot2c_f32_bf16 v45, v103, v11
    v_dot2c_f32_bf16 v46, v107, v11
    v_dot2c_f32_bf16 v47, v111, v11
    buffer_load_dwordx4 v[96:99], v1, s[60:63], s11 offen offset:0
    buffer_load_dwordx4 v[100:103], v1, s[60:63], s11 offen offset:1024
    buffer_load_dwordx4 v[104:107], v1, s[60:63], s11 offen offset:2048
    buffer_load_dwordx4 v[108:111], v1, s[60:63], s11 offen offset:3072
    v_add_f32_dpp v44, v44, v44 row_ror:8 row_mask:0xf bank_mask:0xf
    v_add_f32_dpp v45, v45, v45 row_ror:8 row_mask:0xf bank_mask:0xf
    v_add_f32_dpp v46, v46, v46 row_ror:8 row_mask:0xf bank_mask:0xf
    v_add_f32_dpp v47, v47, v47 row_ror:8 row_mask:0xf bank_mask:0xf
    v_add_f32_dpp v44, v44, v44 row_ror:4 row_mask:0xf bank_mask:0xf
    v_add_f32_dpp v45, v45, v45 row_ror:4 row_mask:0xf bank_mask:0xf
    v_add_f32_dpp v46, v46, v46 row_ror:4 row_mask:0xf bank_mask:0xf
    v_add_f32_dpp v47, v47, v47 row_ror:4 row_mask:0xf bank_mask:0xf
    v_add_f32_dpp v44, v44, v44 row_ror:2 row_mask:0xf bank_mask:0xf
    v_add_f32_dpp v45, v45, v45 row_ror:2 row_mask:0xf bank_mask:0xf
    v_add_f32_dpp v46, v46, v46 row_ror:2 row_mask:0xf bank_mask:0xf
    v_add_f32_dpp v47, v47, v47 row_ror:2 row_mask:0xf bank_mask:0xf
    v_add_f32_dpp v44, v44, v44 row_ror:1 row_mask:0xf bank_mask:0xf
    v_add_f32_dpp v45, v45, v45 row_ror:1 row_mask:0xf bank_mask:0xf
    v_add_f32_dpp v46, v46, v46 row_ror:1 row_mask:0xf bank_mask:0xf
    v_add_f32_dpp v47, v47, v47 row_ror:1 row_mask:0xf bank_mask:0xf
    v_max3_f32 v52, v44, v45, v20
    v_max3_f32 v52, v52, v46, v47
    v_mul_f32 v53, s8, v52
    v_fma_f32 v54, v20, s8, -v53
    v_fma_f32 v44, v44, s8, -v53
    v_fma_f32 v45, v45, s8, -v53
    v_fma_f32 v46, v46, s8, -v53
    v_fma_f32 v47, v47, s8, -v53
    v_exp_f32 v54, v54
    v_exp_f32 v44, v44
    v_exp_f32 v45, v45
    v_exp_f32 v46, v46
    v_exp_f32 v47, v47
    v_mov_b32 v20, v52
    v_fma_f32 v21, v21, v54, v44
    v_mul_f32 v12, v12, v54
    v_mul_f32 v13, v13, v54
    v_mul_f32 v14, v14, v54
    v_mul_f32 v15, v15, v54
    v_mul_f32 v16, v16, v54
    v_mul_f32 v17, v17, v54
    v_mul_f32 v18, v18, v54
    v_mul_f32 v19, v19, v54
    v_add_f32 v21, v21, v45
    v_add_f32 v21, v21, v46
    v_add_f32 v21, v21, v47
    v_cvt_pk_bf16_f32 v48, v44, 0
    v_cvt_pk_bf16_f32 v49, v45, 0
    v_cvt_pk_bf16_f32 v50, v46, 0
    v_cvt_pk_bf16_f32 v51, v47, 0
    v_lshlrev_b32 v44, 16, v48
    v_lshlrev_b32 v45, 16, v49
    v_lshlrev_b32 v46, 16, v50
    v_lshlrev_b32 v47, 16, v51
    s_waitcnt vmcnt(12)
    v_dot2c_f32_bf16 v12, v112, v48
    v_dot2c_f32_bf16 v13, v112, v44
    v_dot2c_f32_bf16 v14, v113, v48
    v_dot2c_f32_bf16 v15, v113, v44
    v_dot2c_f32_bf16 v16, v114, v48
    v_dot2c_f32_bf16 v17, v114, v44
    v_dot2c_f32_bf16 v18, v115, v48
    v_dot2c_f32_bf16 v19, v115, v44
    v_dot2c_f32_bf16 v12, v116, v49
    v_dot2c_f32_bf16 v13, v116, v45
    v_dot2c_f32_bf16 v14, v117, v49
    v_dot2c_f32_bf16 v15, v117, v45
    v_dot2c_f32_bf16 v16, v118, v49
    v_dot2c_f32_bf16 v17, v118, v45
    v_dot2c_f32_bf16 v18, v119, v49
    v_dot2c_f32_bf16 v19, v119, v45
    v_dot2c_f32_bf16 v12, v120, v50
    v_dot2c_f32_bf16 v13, v120, v46
    v_dot2c_f32_bf16 v14, v121, v50
    v_dot2c_f32_bf16 v15, v121, v46
    v_dot2c_f32_bf16 v16, v122, v50
    v_dot2c_f32_bf16 v17, v122, v46
    v_dot2c_f32_bf16 v18, v123, v50
    v_dot2c_f32_bf16 v19, v123, v46
    v_dot2c_f32_bf16 v12, v124, v51
    v_dot2c_f32_bf16 v13, v124, v47
    v_dot2c_f32_bf16 v14, v125, v51
    v_dot2c_f32_bf16 v15, v125, v47
    v_dot2c_f32_bf16 v16, v126, v51
    v_dot2c_f32_bf16 v17, v126, v47
    v_dot2c_f32_bf16 v18, v127, v51
    v_dot2c_f32_bf16 v19, v127, v47
    buffer_load_dwordx4 v[112:115], v1, s[64:67], s11 offen offset:0
    buffer_load_dwordx4 v[116:119], v1, s[64:67], s11 offen offset:1024
    buffer_load_dwordx4 v[120:123], v1, s[64:67], s11 offen offset:2048
    buffer_load_dwordx4 v[124:127], v1, s[64:67], s11 offen offset:3072
    s_branch L_disp
L_PF0:
    s_mov_b32 s10, 0
    buffer_load_dwordx4 v[64:67], v1, s[44:47], s10 offen offset:0 nt
    buffer_load_dwordx4 v[68:71], v1, s[44:47], s10 offen offset:1024 nt
    buffer_load_dwordx4 v[72:75], v1, s[44:47], s10 offen offset:2048 nt
    buffer_load_dwordx4 v[76:79], v1, s[44:47], s10 offen offset:3072 nt
    buffer_load_dwordx4 v[80:83], v1, s[48:51], s10 offen offset:0 nt
    buffer_load_dwordx4 v[84:87], v1, s[48:51], s10 offen offset:1024 nt
    buffer_load_dwordx4 v[88:91], v1, s[48:51], s10 offen offset:2048 nt
    buffer_load_dwordx4 v[92:95], v1, s[48:51], s10 offen offset:3072 nt
    s_setpc_b64 s[36:37]
L_PF1:
    s_mov_b32 s10, 32768
    buffer_load_dwordx4 v[96:99], v1, s[44:47], s10 offen offset:0 nt
    buffer_load_dwordx4 v[100:103], v1, s[44:47], s10 offen offset:1024 nt
    buffer_load_dwordx4 v[104:107], v1, s[44:47], s10 offen offset:2048 nt
    buffer_load_dwordx4 v[108:111], v1, s[44:47], s10 offen offset:3072 nt
    buffer_load_dwordx4 v[112:115], v1, s[48:51], s10 offen offset:0 nt
    buffer_load_dwordx4 v[116:119], v1, s[48:51], s10 offen offset:1024 nt
    buffer_load_dwordx4 v[120:123], v1, s[48:51], s10 offen offset:2048 nt
    buffer_load_dwordx4 v[124:127], v1, s[48:51], s10 offen offset:3072 nt
    s_setpc_b64 s[36:37]
L_fallback:
    v_bfe_u32 v52, v0, 4, 2
    v_and_b32 v53, 15, v0
    v_lshlrev_b32 v54, 13, v52
    v_lshl_add_u32 v54, v53, 4, v54
    v_lshlrev_b32 v55, 1, v52
    v_lshlrev_b32 v56, 4, v53
    v_lshl_add_u32 v56, v52, 2, v56
    s_mov_b64 s[68:69], s[22:23]
    s_mov_b64 s[72:73], s[16:17]
    v_mov_b32 v44, 0
    v_mov_b32 v45, 0
    v_mov_b32 v46, 0
    v_mov_b32 v47, 0
    v_mov_b32 v48, 0
    v_mov_b32 v49, 0
    v_mov_b32 v50, 0
    v_mov_b32 v51, 0
    s_lshl_b32 s7, s3, 8
    s_mov_b32 s14, 0
L_fb0:
    buffer_load_dwordx4 v[128:131], v54, s[68:71], s7 offen
    buffer_load_ushort v132, v55, s[72:75], s14 offen
    s_waitcnt vmcnt(0)
    v_lshlrev_b32 v133, 16, v132
    v_dot2c_f32_bf16 v44, v128, v132
    v_dot2c_f32_bf16 v45, v128, v133
    v_dot2c_f32_bf16 v46, v129, v132
    v_dot2c_f32_bf16 v47, v129, v133
    v_dot2c_f32_bf16 v48, v130, v132
    v_dot2c_f32_bf16 v49, v130, v133
    v_dot2c_f32_bf16 v50, v131, v132
    v_dot2c_f32_bf16 v51, v131, v133
    s_add_u32 s7, s7, 0x8000
    s_add_u32 s14, s14, 8
    s_cmp_lt_u32 s14, 1024
    s_cbranch_scc1 L_fb0
    s_nop 3
    s_nop 1
    v_permlane32_swap_b32 v44, v48
    v_permlane32_swap_b32 v45, v49
    v_permlane32_swap_b32 v46, v50
    v_permlane32_swap_b32 v47, v51
    s_nop 1
    v_add_f32 v44, v44, v48
    v_add_f32 v45, v45, v49
    v_add_f32 v46, v46, v50
    v_add_f32 v47, v47, v51
    s_nop 1
    v_permlane16_swap_b32 v44, v46
    v_permlane16_swap_b32 v45, v47
    s_nop 1
    v_add_f32 v44, v44, v46
    v_add_f32 v45, v45, v47
    v_cvt_pk_bf16_f32 v44, v44, v45
    ds_write_b32 v56, v44 offset:0
    s_mov_b64 s[68:69], s[32:33]
    s_mov_b64 s[72:73], s[26:27]
    v_mov_b32 v44, 0
    v_mov_b32 v45, 0
    v_mov_b32 v46, 0
    v_mov_b32 v47, 0
    v_mov_b32 v48, 0
    v_mov_b32 v49, 0
    v_mov_b32 v50, 0
    v_mov_b32 v51, 0
    s_lshl_b32 s7, s3, 8
    s_mov_b32 s14, 0
L_fb1:
    buffer_load_dwordx4 v[128:131], v54, s[68:71], s7 offen
    buffer_load_ushort v132, v55, s[72:75], s14 offen
    s_waitcnt vmcnt(0)
    v_lshlrev_b32 v133, 16, v132
    v_dot2c_f32_bf16 v44, v128, v132
    v_dot2c_f32_bf16 v45, v128, v133
    v_dot2c_f32_bf16 v46, v129, v132
    v_dot2c_f32_bf16 v47, v129, v133
    v_dot2c_f32_bf16 v48, v130, v132
    v_dot2c_f32_bf16 v49, v130, v133
    v_dot2c_f32_bf16 v50, v131, v132
    v_dot2c_f32_bf16 v51, v131, v133
    s_add_u32 s7, s7, 0x8000
    s_add_u32 s14, s14, 8
    s_cmp_lt_u32 s14, 1024
    s_cbranch_scc1 L_fb1
    s_nop 3
    s_nop 1
    v_permlane32_swap_b32 v44, v48
    v_permlane32_swap_b32 v45, v49
    v_permlane32_swap_b32 v46, v50
    v_permlane32_swap_b32 v47, v51
    s_nop 1
    v_add_f32 v44, v44, v48
    v_add_f32 v45, v45, v49
    v_add_f32 v46, v46, v50
    v_add_f32 v47, v47, v51
    s_nop 1
    v_permlane16_swap_b32 v44, v46
    v_permlane16_swap_b32 v45, v47
    s_nop 1
    v_add_f32 v44, v44, v46
    v_add_f32 v45, v45, v47
    v_cvt_pk_bf16_f32 v44, v44, v45
    ds_write_b32 v56, v44 offset:256
    s_branch L_qdone
L_loop1:
    s_waitcnt vmcnt(12)
    v_dot2_f32_bf16 v44, v64, v8, 0
    v_dot2_f32_bf16 v45, v68, v8, 0
    v_dot2_f32_bf16 v46, v72, v8, 0
    v_dot2_f32_bf16 v47, v76, v8, 0
    v_dot2c_f32_bf16 v44, v65, v9
    v_dot2c_f32_bf16 v45, v69, v9
    v_dot2c_f32_bf16 v46, v73, v9
    v_dot2c_f32_bf16 v47, v77, v9
    v_dot2c_f32_bf16 v44, v66, v10
    v_dot2c_f32_bf16 v45, v70, v10
    v_dot2c_f32_bf16 v46, v74, v10
    v_dot2c_f32_bf16 v47, v78, v10
    v_dot2c_f32_bf16 v44, v67, v11
    v_dot2c_f32_bf16 v45, v71, v11
    v_dot2c_f32_bf16 v46, v75, v11
    v_dot2c_f32_bf16 v47, v79, v11
    buffer_load_dwordx4 v[64:67], v1, s[44:47], s10 offen offset:0 nt
    buffer_load_dwordx4 v[68:71], v1, s[44:47], s10 offen offset:1024 nt
    buffer_load_dwordx4 v[72:75], v1, s[44:47], s10 offen offset:2048 nt
    buffer_load_dwordx4 v[76:79], v1, s[44:47], s10 offen offset:3072 nt
    v_add_f32_dpp v44, v44, v44 row_ror:8 row_mask:0xf bank_mask:0xf
    v_add_f32_dpp v45, v45, v45 row_ror:8 row_mask:0xf bank_mask:0xf
    v_add_f32_dpp v46, v46, v46 row_ror:8 row_mask:0xf bank_mask:0xf
    v_add_f32_dpp v47, v47, v47 row_ror:8 row_mask:0xf bank_mask:0xf
    v_add_f32_dpp v44, v44, v44 row_ror:4 row_mask:0xf bank_mask:0xf
    v_add_f32_dpp v45, v45, v45 row_ror:4 row_mask:0xf bank_mask:0xf
    v_add_f32_dpp v46, v46, v46 row_ror:4 row_mask:0xf bank_mask:0xf
    v_add_f32_dpp v47, v47, v47 row_ror:4 row_mask:0xf bank_mask:0xf
    v_add_f32_dpp v44, v44, v44 row_ror:2 row_mask:0xf bank_mask:0xf
    v_add_f32_dpp v45, v45, v45 row_ror:2 row_mask:0xf bank_mask:0xf
    v_add_f32_dpp v46, v46, v46 row_ror:2 row_mask:0xf bank_mask:0xf
    v_add_f32_dpp v47, v47, v47 row_ror:2 row_mask:0xf bank_mask:0xf
    v_add_f32_dpp v44, v44, v44 row_ror:1 row_mask:0xf bank_mask:0xf
    v_add_f32_dpp v45, v45, v45 row_ror:1 row_mask:0xf bank_mask:0xf
    v_add_f32_dpp v46, v46, v46 row_ror:1 row_mask:0xf bank_mask:0xf
    v_add_f32_dpp v47, v47, v47 row_ror:1 row_mask:0xf bank_mask:0xf
    v_max3_f32 v52, v44, v45, v20
    v_max3_f32 v52, v52, v46, v47
    v_mul_f32 v53, s8, v52
    v_fma_f32 v54, v20, s8, -v53
    v_fma_f32 v44, v44, s8, -v53
    v_fma_f32 v45, v45, s8, -v53
    v_fma_f32 v46, v46, s8, -v53
    v_fma_f32 v47, v47, s8, -v53
    v_exp_f32 v54, v54
    v_exp_f32 v44, v44
    v_exp_f32 v45, v45
    v_exp_f32 v46, v46
    v_exp_f32 v47, v47
    v_mov_b32 v20, v52
    v_fma_f32 v21, v21, v54, v44
    v_mul_f32 v12, v12, v54
    v_mul_f32 v13, v13, v54
    v_mul_f32 v14, v14, v54
    v_mul_f32 v15, v15, v54
    v_mul_f32 v16, v16, v54
    v_mul_f32 v17, v17, v54
    v_mul_f32 v18, v18, v54
    v_mul_f32 v19, v19, v54
    v_add_f32 v21, v21, v45
    v_add_f32 v21, v21, v46
    v_add_f32 v21, v21, v47
    v_cvt_pk_bf16_f32 v48, v44, 0
    v_cvt_pk_bf16_f32 v49, v45, 0
    v_cvt_pk_bf16_f32 v50, v46, 0
    v_cvt_pk_bf16_f32 v51, v47, 0
    v_lshlrev_b32 v44, 16, v48
    v_lshlrev_b32 v45, 16, v49
    v_lshlrev_b32 v46, 16, v50
    v_lshlrev_b32 v47, 16, v51
    s_waitcnt vmcnt(12)
    v_dot2c_f32_bf16 v12, v80, v48
    v_dot2c_f32_bf16 v13, v80, v44
    v_dot2c_f32_bf16 v14, v81, v48
    v_dot2c_f32_bf16 v15, v81, v44
    v_dot2c_f32_bf16 v16, v82, v48
    v_dot2c_f32_bf16 v17, v82, v44
    v_dot2c_f32_bf16 v18, v83, v48
    v_dot2c_f32_bf16 v19, v83, v44
    v_dot2c_f32_bf16 v12, v84, v49
    v_dot2c_f32_bf16 v13, v84, v45
    v_dot2c_f32_bf16 v14, v85, v49
    v_dot2c_f32_bf16 v15, v85, v45
    v_dot2c_f32_bf16 v16, v86, v49
    v_dot2c_f32_bf16 v17, v86, v45
    v_dot2c_f32_bf16 v18, v87, v49
    v_dot2c_f32_bf16 v19, v87, v45
    v_dot2c_f32_bf16 v12, v88, v50
    v_dot2c_f32_bf16 v13, v88, v46
    v_dot2c_f32_bf16 v14, v89, v50
    v_dot2c_f32_bf16 v15, v89, v46
    v_dot2c_f32_bf16 v16, v90, v50
    v_dot2c_f32_bf16 v17, v90, v46
    v_dot2c_f32_bf16 v18, v91, v50
    v_dot2c_f32_bf16 v19, v91, v46
    v_dot2c_f32_bf16 v12, v92, v51
    v_dot2c_f32_bf16 v13, v92, v47
    v_dot2c_f32_bf16 v14, v93, v51
    v_dot2c_f32_bf16 v15, v93, v47
    v_dot2c_f32_bf16 v16, v94, v51
    v_dot2c_f32_bf16 v17, v94, v47
    v_dot2c_f32_bf16 v18, v95, v51
    v_dot2c_f32_bf16 v19, v95, v47
    buffer_load_dwordx4 v[80:83], v1, s[48:51], s10 offen offset:0 nt
    buffer_load_dwordx4 v[84:87], v1, s[48:51], s10 offen offset:1024 nt
    buffer_load_dwordx4 v[88:91], v1, s[48:51], s10 offen offset:2048 nt
    buffer_load_dwordx4 v[92:95], v1, s[48:51], s10 offen offset:3072 nt
    s_waitcnt vmcnt(12)
    v_dot2_f32_bf16 v44, v96, v22, 0
    v_dot2_f32_bf16 v45, v100, v22, 0
    v_dot2_f32_bf16 v46, v104, v22, 0
    v_dot2_f32_bf16 v47, v108, v22, 0
    v_dot2c_f32_bf16 v44, v97, v23
    v_dot2c_f32_bf16 v45, v101, v23
    v_dot2c_f32_bf16 v46, v105, v23
    v_dot2c_f32_bf16 v47, v109, v23
    v_dot2c_f32_bf16 v44, v98, v24
    v_dot2c_f32_bf16 v45, v102, v24
    v_dot2c_f32_bf16 v46, v106, v24
    v_dot2c_f32_bf16 v47, v110, v24
    v_dot2c_f32_bf16 v44, v99, v25
    v_dot2c_f32_bf16 v45, v103, v25
    v_dot2c_f32_bf16 v46, v107, v25
    v_dot2c_f32_bf16 v47, v111, v25
    buffer_load_dwordx4 v[96:99], v1, s[60:63], s11 offen offset:0
    buffer_load_dwordx4 v[100:103], v1, s[60:63], s11 offen offset:1024
    buffer_load_dwordx4 v[104:107], v1, s[60:63], s11 offen offset:2048
    buffer_load_dwordx4 v[108:111], v1, s[60:63], s11 offen offset:3072
    v_add_f32_dpp v44, v44, v44 row_ror:8 row_mask:0xf bank_mask:0xf
    v_add_f32_dpp v45, v45, v45 row_ror:8 row_mask:0xf bank_mask:0xf
    v_add_f32_dpp v46, v46, v46 row_ror:8 row_mask:0xf bank_mask:0xf
    v_add_f32_dpp v47, v47, v47 row_ror:8 row_mask:0xf bank_mask:0xf
    v_add_f32_dpp v44, v44, v44 row_ror:4 row_mask:0xf bank_mask:0xf
    v_add_f32_dpp v45, v45, v45 row_ror:4 row_mask:0xf bank_mask:0xf
    v_add_f32_dpp v46, v46, v46 row_ror:4 row_mask:0xf bank_mask:0xf
    v_add_f32_dpp v47, v47, v47 row_ror:4 row_mask:0xf bank_mask:0xf
    v_add_f32_dpp v44, v44, v44 row_ror:2 row_mask:0xf bank_mask:0xf
    v_add_f32_dpp v45, v45, v45 row_ror:2 row_mask:0xf bank_mask:0xf
    v_add_f32_dpp v46, v46, v46 row_ror:2 row_mask:0xf bank_mask:0xf
    v_add_f32_dpp v47, v47, v47 row_ror:2 row_mask:0xf bank_mask:0xf
    v_add_f32_dpp v44, v44, v44 row_ror:1 row_mask:0xf bank_mask:0xf
    v_add_f32_dpp v45, v45, v45 row_ror:1 row_mask:0xf bank_mask:0xf
    v_add_f32_dpp v46, v46, v46 row_ror:1 row_mask:0xf bank_mask:0xf
    v_add_f32_dpp v47, v47, v47 row_ror:1 row_mask:0xf bank_mask:0xf
    v_max3_f32 v52, v44, v45, v34
    v_max3_f32 v52, v52, v46, v47
    v_mul_f32 v53, s8, v52
    v_fma_f32 v54, v34, s8, -v53
    v_fma_f32 v44, v44, s8, -v53
    v_fma_f32 v45, v45, s8, -v53
    v_fma_f32 v46, v46, s8, -v53
    v_fma_f32 v47, v47, s8, -v53
    v_exp_f32 v54, v54
    v_exp_f32 v44, v44
    v_exp_f32 v45, v45
    v_exp_f32 v46, v46
    v_exp_f32 v47, v47
    v_mov_b32 v34, v52
    v_fma_f32 v35, v35, v54, v44
    v_mul_f32 v26, v26, v54
    v_mul_f32 v27, v27, v54
    v_mul_f32 v28, v28, v54
    v_mul_f32 v29, v29, v54
    v_mul_f32 v30, v30, v54
    v_mul_f32 v31, v31, v54
    v_mul_f32 v32, v32, v54
    v_mul_f32 v33, v33, v54
    v_add_f32 v35, v35, v45
    v_add_f32 v35, v35, v46
    v_add_f32 v35, v35, v47
    v_cvt_pk_bf16_f32 v48, v44, 0
    v_cvt_pk_bf16_f32 v49, v45, 0
    v_cvt_pk_bf16_f32 v50, v46, 0
    v_cvt_pk_bf16_f32 v51, v47, 0
    v_lshlrev_b32 v44, 16, v48
    v_lshlrev_b32 v45, 16, v49
    v_lshlrev_b32 v46, 16, v50
    v_lshlrev_b32 v47, 16, v51
    s_waitcnt vmcnt(12)
    v_dot2c_f32_bf16 v26, v112, v48
    v_dot2c_f32_bf16 v27, v112, v44
    v_dot2c_f32_bf16 v28, v113, v48
    v_dot2c_f32_bf16 v29, v113, v44
    v_dot2c_f32_bf16 v30, v114, v48
    v_dot2c_f32_bf16 v31, v114, v44
    v_dot2c_f32_bf16 v32, v115, v48
    v_dot2c_f32_bf16 v33, v115, v44
    v_dot2c_f32_bf16 v26, v116, v49
    v_dot2c_f32_bf16 v27, v116, v45
    v_dot2c_f32_bf16 v28, v117, v49
    v_dot2c_f32_bf16 v29, v117, v45
    v_dot2c_f32_bf16 v30, v118, v49
    v_dot2c_f32_bf16 v31, v118, v45
    v_dot2c_f32_bf16 v32, v119, v49
    v_dot2c_f32_bf16 v33, v119, v45
    v_dot2c_f32_bf16 v26, v120, v50
    v_dot2c_f32_bf16 v27, v120, v46
    v_dot2c_f32_bf16 v28, v121, v50
    v_dot2c_f32_bf16 v29, v121, v46
    v_dot2c_f32_bf16 v30, v122, v50
    v_dot2c_f32_bf16 v31, v122, v46
    v_dot2c_f32_bf16 v32, v123, v50
    v_dot2c_f32_bf16 v33, v123, v46
    v_dot2c_f32_bf16 v26, v124, v51
    v_dot2c_f32_bf16 v27, v124, v47
    v_dot2c_f32_bf16 v28, v125, v51
    v_dot2c_f32_bf16 v29, v125, v47
    v_dot2c_f32_bf16 v30, v126, v51
    v_dot2c_f32_bf16 v31, v126, v47
    v_dot2c_f32_bf16 v32, v127, v51
    v_dot2c_f32_bf16 v33, v127, v47
    buffer_load_dwordx4 v[112:115], v1, s[64:67], s11 offen offset:0
    buffer_load_dwordx4 v[116:119], v1, s[64:67], s11 offen offset:1024
    buffer_load_dwordx4 v[120:123], v1, s[64:67], s11 offen offset:2048
    buffer_load_dwordx4 v[124:127], v1, s[64:67], s11 offen offset:3072
    s_add_u32 s6, s6, 1
    s_branch L_disp
L_loop2:
    s_waitcnt vmcnt(12)
    v_dot2_f32_bf16 v44, v64, v8, 0
    v_dot2_f32_bf16 v45, v68, v8, 0
    v_dot2_f32_bf16 v46, v72, v8, 0
    v_dot2_f32_bf16 v47, v76, v8, 0
    v_dot2c_f32_bf16 v44, v65, v9
    v_dot2c_f32_bf16 v45, v69, v9
    v_dot2c_f32_bf16 v46, v73, v9
    v_dot2c_f32_bf16 v47, v77, v9
    v_dot2c_f32_bf16 v44, v66, v10
    v_dot2c_f32_bf16 v45, v70, v10
    v_dot2c_f32_bf16 v46, v74, v10
    v_dot2c_f32_bf16 v47, v78, v10
    v_dot2c_f32_bf16 v44, v67, v11
    v_dot2c_f32_bf16 v45, v71, v11
    v_dot2c_f32_bf16 v46, v75, v11
    v_dot2c_f32_bf16 v47, v79, v11
    buffer_load_dwordx4 v[64:67], v1, s[44:47], s10 offen offset:0 nt
    buffer_load_dwordx4 v[68:71], v1, s[44:47], s10 offen offset:1024 nt
    buffer_load_dwordx4 v[72:75], v1, s[44:47], s10 offen offset:2048 nt
    buffer_load_dwordx4 v[76:79], v1, s[44:47], s10 offen offset:3072 nt
    v_add_f32_dpp v44, v44, v44 row_ror:8 row_mask:0xf bank_mask:0xf
    v_add_f32_dpp v45, v45, v45 row_ror:8 row_mask:0xf bank_mask:0xf
    v_add_f32_dpp v46, v46, v46 row_ror:8 row_mask:0xf bank_mask:0xf
    v_add_f32_dpp v47, v47, v47 row_ror:8 row_mask:0xf bank_mask:0xf
    v_add_f32_dpp v44, v44, v44 row_ror:4 row_mask:0xf bank_mask:0xf
    v_add_f32_dpp v45, v45, v45 row_ror:4 row_mask:0xf bank_mask:0xf
    v_add_f32_dpp v46, v46, v46 row_ror:4 row_mask:0xf bank_mask:0xf
    v_add_f32_dpp v47, v47, v47 row_ror:4 row_mask:0xf bank_mask:0xf
    v_add_f32_dpp v44, v44, v44 row_ror:2 row_mask:0xf bank_mask:0xf
    v_add_f32_dpp v45, v45, v45 row_ror:2 row_mask:0xf bank_mask:0xf
    v_add_f32_dpp v46, v46, v46 row_ror:2 row_mask:0xf bank_mask:0xf
    v_add_f32_dpp v47, v47, v47 row_ror:2 row_mask:0xf bank_mask:0xf
    v_add_f32_dpp v44, v44, v44 row_ror:1 row_mask:0xf bank_mask:0xf
    v_add_f32_dpp v45, v45, v45 row_ror:1 row_mask:0xf bank_mask:0xf
    v_add_f32_dpp v46, v46, v46 row_ror:1 row_mask:0xf bank_mask:0xf
    v_add_f32_dpp v47, v47, v47 row_ror:1 row_mask:0xf bank_mask:0xf
    v_max3_f32 v52, v44, v45, v20
    v_max3_f32 v52, v52, v46, v47
    v_mul_f32 v53, s8, v52
    v_fma_f32 v54, v20, s8, -v53
    v_fma_f32 v44, v44, s8, -v53
    v_fma_f32 v45, v45, s8, -v53
    v_fma_f32 v46, v46, s8, -v53
    v_fma_f32 v47, v47, s8, -v53
    v_exp_f32 v54, v54
    v_exp_f32 v44, v44
    v_exp_f32 v45, v45
    v_exp_f32 v46, v46
    v_exp_f32 v47, v47
    v_mov_b32 v20, v52
    v_fma_f32 v21, v21, v54, v44
    v_mul_f32 v12, v12, v54
    v_mul_f32 v13, v13, v54
    v_mul_f32 v14, v14, v54
    v_mul_f32 v15, v15, v54
    v_mul_f32 v16, v16, v54
    v_mul_f32 v17, v17, v54
    v_mul_f32 v18, v18, v54
    v_mul_f32 v19, v19, v54
    v_add_f32 v21, v21, v45
    v_add_f32 v21, v21, v46
    v_add_f32 v21, v21, v47
    v_cvt_pk_bf16_f32 v48, v44, 0
    v_cvt_pk_bf16_f32 v49, v45, 0
    v_cvt_pk_bf16_f32 v50, v46, 0
    v_cvt_pk_bf16_f32 v51, v47, 0
    v_lshlrev_b32 v44, 16, v48
    v_lshlrev_b32 v45, 16, v49
    v_lshlrev_b32 v46, 16, v50
    v_lshlrev_b32 v47, 16, v51
    s_waitcnt vmcnt(12)
    v_dot2c_f32_bf16 v12, v80, v48
    v_dot2c_f32_bf16 v13, v80, v44
    v_dot2c_f32_bf16 v14, v81, v48
    v_dot2c_f32_bf16 v15, v81, v44
    v_dot2c_f32_bf16 v16, v82, v48
    v_dot2c_f32_bf16 v17, v82, v44
    v_dot2c_f32_bf16 v18, v83, v48
    v_dot2c_f32_bf16 v19, v83, v44
    v_dot2c_f32_bf16 v12, v84, v49
    v_dot2c_f32_bf16 v13, v84, v45
    v_dot2c_f32_bf16 v14, v85, v49
    v_dot2c_f32_bf16 v15, v85, v45
    v_dot2c_f32_bf16 v16, v86, v49
    v_dot2c_f32_bf16 v17, v86, v45
    v_dot2c_f32_bf16 v18, v87, v49
    v_dot2c_f32_bf16 v19, v87, v45
    v_dot2c_f32_bf16 v12, v88, v50
    v_dot2c_f32_bf16 v13, v88, v46
    v_dot2c_f32_bf16 v14, v89, v50
    v_dot2c_f32_bf16 v15, v89, v46
    v_dot2c_f32_bf16 v16, v90, v50
    v_dot2c_f32_bf16 v17, v90, v46
    v_dot2c_f32_bf16 v18, v91, v50
    v_dot2c_f32_bf16 v19, v91, v46
    v_dot2c_f32_bf16 v12, v92, v51
    v_dot2c_f32_bf16 v13, v92, v47
    v_dot2c_f32_bf16 v14, v93, v51
    v_dot2c_f32_bf16 v15, v93, v47
    v_dot2c_f32_bf16 v16, v94, v51
    v_dot2c_f32_bf16 v17, v94, v47
    v_dot2c_f32_bf16 v18, v95, v51
    v_dot2c_f32_bf16 v19, v95, v47
    buffer_load_dwordx4 v[80:83], v1, s[48:51], s10 offen offset:0 nt
    buffer_load_dwordx4 v[84:87], v1, s[48:51], s10 offen offset:1024 nt
    buffer_load_dwordx4 v[88:91], v1, s[48:51], s10 offen offset:2048 nt
    buffer_load_dwordx4 v[92:95], v1, s[48:51], s10 offen offset:3072 nt
    s_waitcnt vmcnt(12)
    v_dot2_f32_bf16 v44, v96, v8, 0
    v_dot2_f32_bf16 v45, v100, v8, 0
    v_dot2_f32_bf16 v46, v104, v8, 0
    v_dot2_f32_bf16 v47, v108, v8, 0
    v_dot2c_f32_bf16 v44, v97, v9
    v_dot2c_f32_bf16 v45, v101, v9
    v_dot2c_f32_bf16 v46, v105, v9
    v_dot2c_f32_bf16 v47, v109, v9
    v_dot2c_f32_bf16 v44, v98, v10
    v_dot2c_f32_bf16 v45, v102, v10
    v_dot2c_f32_bf16 v46, v106, v10
    v_dot2c_f32_bf16 v47, v110, v10
    v_dot2c_f32_bf16 v44, v99, v11
    v_dot2c_f32_bf16 v45, v103, v11
    v_dot2c_f32_bf16 v46, v107, v11
    v_dot2c_f32_bf16 v47, v111, v11
    buffer_load_dwordx4 v[96:99], v1, s[60:63], s11 offen offset:0 nt
    buffer_load_dwordx4 v[100:103], v1, s[60:63], s11 offen offset:1024 nt
    buffer_load_dwordx4 v[104:107], v1, s[60:63], s11 offen offset:2048 nt
    buffer_load_dwordx4 v[108:111], v1, s[60:63], s11 offen offset:3072 nt
    v_add_f32_dpp v44, v44, v44 row_ror:8 row_mask:0xf bank_mask:0xf
    v_add_f32_dpp v45, v45, v45 row_ror:8 row_mask:0xf bank_mask:0xf
    v_add_f32_dpp v46, v46, v46 row_ror:8 row_mask:0xf bank_mask:0xf
    v_add_f32_dpp v47, v47, v47 row_ror:8 row_mask:0xf bank_mask:0xf
    v_add_f32_dpp v44, v44, v44 row_ror:4 row_mask:0xf bank_mask:0xf
    v_add_f32_dpp v45, v45, v45 row_ror:4 row_mask:0xf bank_mask:0xf
    v_add_f32_dpp v46, v46, v46 row_ror:4 row_mask:0xf bank_mask:0xf
    v_add_f32_dpp v47, v47, v47 row_ror:4 row_mask:0xf bank_mask:0xf
    v_add_f32_dpp v44, v44, v44 row_ror:2 row_mask:0xf bank_mask:0xf
    v_add_f32_dpp v45, v45, v45 row_ror:2 row_mask:0xf bank_mask:0xf
    v_add_f32_dpp v46, v46, v46 row_ror:2 row_mask:0xf bank_mask:0xf
    v_add_f32_dpp v47, v47, v47 row_ror:2 row_mask:0xf bank_mask:0xf
    v_add_f32_dpp v44, v44, v44 row_ror:1 row_mask:0xf bank_mask:0xf
    v_add_f32_dpp v45, v45, v45 row_ror:1 row_mask:0xf bank_mask:0xf
    v_add_f32_dpp v46, v46, v46 row_ror:1 row_mask:0xf bank_mask:0xf
    v_add_f32_dpp v47, v47, v47 row_ror:1 row_mask:0xf bank_mask:0xf
    v_max3_f32 v52, v44, v45, v20
    v_max3_f32 v52, v52, v46, v47
    v_mul_f32 v53, s8, v52
    v_fma_f32 v54, v20, s8, -v53
    v_fma_f32 v44, v44, s8, -v53
    v_fma_f32 v45, v45, s8, -v53
    v_fma_f32 v46, v46, s8, -v53
    v_fma_f32 v47, v47, s8, -v53
    v_exp_f32 v54, v54
    v_exp_f32 v44, v44
    v_exp_f32 v45, v45
    v_exp_f32 v46, v46
    v_exp_f32 v47, v47
    v_mov_b32 v20, v52
    v_fma_f32 v21, v21, v54, v44
    v_mul_f32 v12, v12, v54
    v_mul_f32 v13, v13, v54
    v_mul_f32 v14, v14, v54
    v_mul_f32 v15, v15, v54
    v_mul_f32 v16, v16, v54
    v_mul_f32 v17, v17, v54
    v_mul_f32 v18, v18, v54
    v_mul_f32 v19, v19, v54
    v_add_f32 v21, v21, v45
    v_add_f32 v21, v21, v46
    v_add_f32 v21, v21, v47
    v_cvt_pk_bf16_f32 v48, v44, 0
    v_cvt_pk_bf16_f32 v49, v45, 0
    v_cvt_pk_bf16_f32 v50, v46, 0
    v_cvt_pk_bf16_f32 v51, v47, 0
    v_lshlrev_b32 v44, 16, v48
    v_lshlrev_b32 v45, 16, v49
    v_lshlrev_b32 v46, 16, v50
    v_lshlrev_b32 v47, 16, v51
    s_waitcnt vmcnt(12)
    v_dot2c_f32_bf16 v12, v112, v48
    v_dot2c_f32_bf16 v13, v112, v44
    v_dot2c_f32_bf16 v14, v113, v48
    v_dot2c_f32_bf16 v15, v113, v44
    v_dot2c_f32_bf16 v16, v114, v48
    v_dot2c_f32_bf16 v17, v114, v44
    v_dot2c_f32_bf16 v18, v115, v48
    v_dot2c_f32_bf16 v19, v115, v44
    v_dot2c_f32_bf16 v12, v116, v49
    v_dot2c_f32_bf16 v13, v116, v45
    v_dot2c_f32_bf16 v14, v117, v49
    v_dot2c_f32_bf16 v15, v117, v45
    v_dot2c_f32_bf16 v16, v118, v49
    v_dot2c_f32_bf16 v17, v118, v45
    v_dot2c_f32_bf16 v18, v119, v49
    v_dot2c_f32_bf16 v19, v119, v45
    v_dot2c_f32_bf16 v12, v120, v50
    v_dot2c_f32_bf16 v13, v120, v46
    v_dot2c_f32_bf16 v14, v121, v50
    v_dot2c_f32_bf16 v15, v121, v46
    v_dot2c_f32_bf16 v16, v122, v50
    v_dot2c_f32_bf16 v17, v122, v46
    v_dot2c_f32_bf16 v18, v123, v50
    v_dot2c_f32_bf16 v19, v123, v46
    v_dot2c_f32_bf16 v12, v124, v51
    v_dot2c_f32_bf16 v13, v124, v47
    v_dot2c_f32_bf16 v14, v125, v51
    v_dot2c_f32_bf16 v15, v125, v47
    v_dot2c_f32_bf16 v16, v126, v51
    v_dot2c_f32_bf16 v17, v126, v47
    v_dot2c_f32_bf16 v18, v127, v51
    v_dot2c_f32_bf16 v19, v127, v47
    buffer_load_dwordx4 v[112:115], v1, s[64:67], s11 offen offset:0 nt
    buffer_load_dwordx4 v[116:119], v1, s[64:67], s11 offen offset:1024 nt
    buffer_load_dwordx4 v[120:123], v1, s[64:67], s11 offen offset:2048 nt
    buffer_load_dwordx4 v[124:127], v1, s[64:67], s11 offen offset:3072 nt
    s_add_u32 s6, s6, 1
L_disp:
    s_cmp_eq_u32 s6, 0
    s_cbranch_scc1 L_T0_0
    s_cmp_eq_u32 s6, 1
    s_cbranch_scc1 L_T0_1
    s_cmp_eq_u32 s6, 2
    s_cbranch_scc1 L_T0_2
    s_cmp_eq_u32 s6, 3
    s_cbranch_scc1 L_T0_3
    s_cmp_eq_u32 s6, 4
    s_cbranch_scc1 L_T0_4
    s_cmp_eq_u32 s6, 5
    s_cbranch_scc1 L_T0_5
    s_cmp_eq_u32 s6, 6
    s_cbranch_scc1 L_T0_6
    s_cmp_eq_u32 s6, 7
    s_cbranch_scc1 L_T0_7
    s_cmp_eq_u32 s6, 8
    s_cbranch_scc1 L_T0_8
    s_cmp_eq_u32 s6, 16
    s_cbranch_scc1 L_T1_0
    s_cmp_eq_u32 s6, 17
    s_cbranch_scc1 L_T1_1
    s_cmp_eq_u32 s6, 18
    s_cbranch_scc1 L_T1_2
    s_cmp_eq_u32 s6, 19
    s_cbranch_scc1 L_T1_3
    s_cmp_eq_u32 s6, 20
    s_cbranch_scc1 L_T1_4
    s_cmp_eq_u32 s6, 21
    s_cbranch_scc1 L_T1_5
    s_cmp_eq_u32 s6, 22
    s_cbranch_scc1 L_T1_6
    s_cmp_eq_u32 s6, 23
    s_cbranch_scc1 L_T1_7
    s_cmp_eq_u32 s6, 24
    s_cbranch_scc1 L_T1_8
    s_branch L_Tend
L_T0_0:
    s_mov_b32 s10, 98304
    s_mov_b32 s11, 32768
    s_branch L_loop1
L_T0_1:
    s_mov_b32 s10, 131072
    s_mov_b32 s11, 65536
    s_branch L_loop1
L_T0_2:
    s_mov_b32 s10, 163840
    s_mov_b32 s11, 98304
    s_branch L_loop1
L_T0_3:
    s_mov_b64 s[60:61], s[44:45]
    s_mov_b64 s[62:63], s[46:47]
    s_mov_b64 s[64:65], s[48:49]
    s_mov_b64 s[66:67], s[50:51]
    s_mov_b32 s10, 196608
    s_mov_b32 s11, 229376
    s_branch L_loop1
L_T0_4:
    s_nop 3
    v_swap_b32 v12, v26
    v_swap_b32 v13, v27
    v_swap_b32 v14, v28
    v_swap_b32 v15, v29
    v_swap_b32 v16, v30
    v_swap_b32 v17, v31
    v_swap_b32 v18, v32
    v_swap_b32 v19, v33
    v_swap_b32 v20, v34
    v_swap_b32 v21, v35
    s_mov_b32 s12, 0
    s_call_b64 s[36:37], L_O1
    s_mov_b64 exec, 1
    ds_add_u32 v4, v5 offset:16644
    s_mov_b64 exec, -1
    v_mov_b32 v12, v26
    v_mov_b32 v13, v27
    v_mov_b32 v14, v28
    v_mov_b32 v15, v29
    v_mov_b32 v16, v30
    v_mov_b32 v17, v31
    v_mov_b32 v18, v32
    v_mov_b32 v19, v33
    v_mov_b32 v20, v34
    v_mov_b32 v21, v35
    s_call_b64 s[36:37], L_IwoA
    s_mov_b32 s10, 262144
    s_mov_b32 s11, 294912
    s_branch L_loop2
L_T0_5:
    s_mov_b32 s10, 327680
    s_mov_b32 s11, 360448
    s_branch L_loop2
L_T0_6:
    s_call_b64 s[36:37], L_MV
    s_call_b64 s[36:37], L_IwoB
    s_mov_b32 s10, 393216
    s_mov_b32 s11, 425984
    s_branch L_loop2
L_T0_7:
    s_mov_b32 s10, 458752
    s_mov_b32 s11, 491520
    s_branch L_loop2
L_T0_8:
    s_nop 3
    v_mov_b32 v26, v12
    v_mov_b32 v27, v13
    v_mov_b32 v28, v14
    v_mov_b32 v29, v15
    v_mov_b32 v30, v16
    v_mov_b32 v31, v17
    v_mov_b32 v32, v18
    v_mov_b32 v33, v19
    v_mov_b32 v34, v20
    v_mov_b32 v35, v21
L_w1:
    ds_read_b32 v63, v4 offset:16644
    s_waitcnt lgkmcnt(0)
    v_readfirstlane_b32 s7, v63
    s_nop 3
    s_cmp_lt_u32 s7, 8
    s_cbranch_scc1 L_w1
    s_call_b64 s[36:37], L_O2
    s_call_b64 s[36:37], L_MV
    v_mov_b32 v12, v26
    v_mov_b32 v13, v27
    v_mov_b32 v14, v28
    v_mov_b32 v15, v29
    v_mov_b32 v16, v30
    v_mov_b32 v17, v31
    v_mov_b32 v18, v32
    v_mov_b32 v19, v33
    v_mov_b32 v20, v34
    v_mov_b32 v21, v35
    s_mov_b32 s10, 524288
    s_mov_b32 s11, 557056
    s_branch L_loop2
L_T1_0:
    s_mov_b32 s10, 98304
    s_mov_b32 s11, 32768
    s_branch L_loop1
L_T1_1:
    s_mov_b32 s10, 131072
    s_mov_b32 s11, 65536
    s_branch L_loop1
L_T1_2:
    s_mov_b32 s10, 163840
    s_mov_b32 s11, 98304
    s_branch L_loop1
L_T1_3:
    s_mov_b64 s[60:61], s[44:45]
    s_mov_b64 s[62:63], s[46:47]
    s_mov_b64 s[64:65], s[48:49]
    s_mov_b64 s[66:67], s[50:51]
    s_mov_b32 s10, 196608
    s_mov_b32 s11, 229376
    s_branch L_loop1
L_T1_4:
    s_nop 3
    v_swap_b32 v12, v26
    v_swap_b32 v13, v27
    v_swap_b32 v14, v28
    v_swap_b32 v15, v29
    v_swap_b32 v16, v30
    v_swap_b32 v17, v31
    v_swap_b32 v18, v32
    v_swap_b32 v19, v33
    v_swap_b32 v20, v34
    v_swap_b32 v21, v35
    s_mov_b32 s12, 0
    s_call_b64 s[36:37], L_O1
    s_mov_b64 exec, 1
    ds_add_u32 v4, v5 offset:16644
    s_mov_b64 exec, -1
    v_mov_b32 v12, v26
    v_mov_b32 v13, v27
    v_mov_b32 v14, v28
    v_mov_b32 v15, v29
    v_mov_b32 v16, v30
    v_mov_b32 v17, v31
    v_mov_b32 v18, v32
    v_mov_b32 v19, v33
    v_mov_b32 v20, v34
    v_mov_b32 v21, v35
    s_mov_b32 s10, 262144
    s_mov_b32 s11, 294912
    s_branch L_loop2
L_T1_5:
    s_call_b64 s[36:37], L_IwoA
    s_mov_b32 s10, 327680
    s_mov_b32 s11, 360448
    s_branch L_loop2
L_T1_6:
    s_mov_b32 s10, 393216
    s_mov_b32 s11, 425984
    s_branch L_loop2
L_T1_7:
    s_call_b64 s[36:37], L_MV
    s_call_b64 s[36:37], L_IwoB
    s_mov_b32 s10, 458752
    s_mov_b32 s11, 491520
    s_branch L_loop2
L_T1_8:
    s_nop 3
    v_mov_b32 v26, v12
    v_mov_b32 v27, v13
    v_mov_b32 v28, v14
    v_mov_b32 v29, v15
    v_mov_b32 v30, v16
    v_mov_b32 v31, v17
    v_mov_b32 v32, v18
    v_mov_b32 v33, v19
    v_mov_b32 v34, v20
    v_mov_b32 v35, v21
L_w2:
    ds_read_b32 v63, v4 offset:16644
    s_waitcnt lgkmcnt(0)
    v_readfirstlane_b32 s7, v63
    s_nop 3
    s_cmp_lt_u32 s7, 8
    s_cbranch_scc1 L_w2
    s_call_b64 s[36:37], L_O2
    s_call_b64 s[36:37], L_MV
    v_mov_b32 v12, v26
    v_mov_b32 v13, v27
    v_mov_b32 v14, v28
    v_mov_b32 v15, v29
    v_mov_b32 v16, v30
    v_mov_b32 v17, v31
    v_mov_b32 v18, v32
    v_mov_b32 v19, v33
    v_mov_b32 v20, v34
    v_mov_b32 v21, v35
    s_mov_b32 s10, 524288
    s_mov_b32 s11, 557056
    s_branch L_loop2
L_Tend:
    s_mov_b32 s12, 1
    s_call_b64 s[36:37], L_O1
    s_mov_b64 exec, 1
    ds_add_u32 v4, v5 offset:16644
    s_mov_b64 exec, -1
L_w3:
    ds_read_b32 v63, v4 offset:16644
    s_waitcnt lgkmcnt(0)
    v_readfirstlane_b32 s7, v63
    s_nop 3
    s_cmp_lt_u32 s7, 16
    s_cbranch_scc1 L_w3
    s_call_b64 s[36:37], L_O2
    s_waitcnt lgkmcnt(0)
    s_mov_b64 exec, 1
    ds_add_u32 v4, v5 offset:16648
    s_mov_b64 exec, -1
L_w4:
    ds_read_b32 v63, v4 offset:16648
    s_waitcnt lgkmcnt(0)
    v_readfirstlane_b32 s7, v63
    s_nop 3
    s_cmp_lt_u32 s7, 8
    s_cbranch_scc1 L_w4
    v_lshlrev_b32 v52, 2, v0
    ds_read_b32 v128, v52 offset:20480
    ds_read_b32 v129, v52 offset:22528
    ds_read_b32 v130, v52 offset:24576
    ds_read_b32 v131, v52 offset:26624
    ds_read_b32 v132, v52 offset:28672
    ds_read_b32 v133, v52 offset:30720
    ds_read_b32 v134, v52 offset:32768
    ds_read_b32 v135, v52 offset:34816
    ds_read_b32 v136, v52 offset:36864
    ds_read_b32 v137, v52 offset:38912
    ds_read_b32 v138, v52 offset:40960
    ds_read_b32 v139, v52 offset:43008
    ds_read_b32 v140, v52 offset:45056
    ds_read_b32 v141, v52 offset:47104
    ds_read_b32 v142, v52 offset:49152
    ds_read_b32 v143, v52 offset:51200
    s_lshl_b32 s14, s9, 11
    s_add_u32 s15, s14, 0x80000
    s_waitcnt lgkmcnt(0)
    v_add_f32 v128, v128, v132
    v_add_f32 v129, v129, v133
    v_add_f32 v130, v130, v134
    v_add_f32 v131, v131, v135
    v_add_f32 v128, v128, v130
    v_add_f32 v129, v129, v131
    v_add_f32 v128, v128, v129
    v_add_f32 v136, v136, v140
    v_add_f32 v137, v137, v141
    v_add_f32 v138, v138, v142
    v_add_f32 v139, v139, v143
    v_add_f32 v136, v136, v138
    v_add_f32 v137, v137, v139
    v_add_f32 v136, v136, v137
    buffer_store_dword v128, v52, s[76:79], s14 offen
    buffer_store_dword v136, v52, s[76:79], s15 offen
    s_branch L_main_fin
L_IwoA:
    s_lshl_b32 s7, s3, 17
    s_add_u32 s68, s24, s7
    s_addc_u32 s69, s25, 0
    s_mov_b32 s70, 0x20000
    s_mov_b32 s71, 0x00020000
    s_mov_b32 s7, 0
    buffer_load_dwordx4 v[192:195], v1, s[68:71], s7 offen offset:0
    buffer_load_dwordx4 v[196:199], v1, s[68:71], s7 offen offset:1024
    buffer_load_dwordx4 v[200:203], v1, s[68:71], s7 offen offset:2048
    buffer_load_dwordx4 v[204:207], v1, s[68:71], s7 offen offset:3072
    s_add_u32 s7, s7, 32768
    buffer_load_dwordx4 v[208:211], v1, s[68:71], s7 offen offset:0
    buffer_load_dwordx4 v[212:215], v1, s[68:71], s7 offen offset:1024
    buffer_load_dwordx4 v[216:219], v1, s[68:71], s7 offen offset:2048
    buffer_load_dwordx4 v[220:223], v1, s[68:71], s7 offen offset:3072
    s_add_u32 s7, s7, 32768
    buffer_load_dwordx4 v[224:227], v1, s[68:71], s7 offen offset:0
    buffer_load_dwordx4 v[228:231], v1, s[68:71], s7 offen offset:1024
    buffer_load_dwordx4 v[232:235], v1, s[68:71], s7 offen offset:2048
    buffer_load_dwordx4 v[236:239], v1, s[68:71], s7 offen offset:3072
    s_add_u32 s7, s7, 32768
    buffer_load_dwordx4 v[240:243], v1, s[68:71], s7 offen offset:0
    buffer_load_dwordx4 v[244:247], v1, s[68:71], s7 offen offset:1024
    buffer_load_dwordx4 v[248:251], v1, s[68:71], s7 offen offset:2048
    buffer_load_dwordx4 v[252:255], v1, s[68:71], s7 offen offset:3072
    s_setpc_b64 s[36:37]
L_IwoB:
    s_lshl_b32 s7, s3, 17
    s_add_u32 s68, s34, s7
    s_addc_u32 s69, s35, 0
    s_mov_b32 s70, 0x20000
    s_mov_b32 s71, 0x00020000
    s_mov_b32 s7, 0
    buffer_load_dwordx4 v[192:195], v1, s[68:71], s7 offen offset:0
    buffer_load_dwordx4 v[196:199], v1, s[68:71], s7 offen offset:1024
    buffer_load_dwordx4 v[200:203], v1, s[68:71], s7 offen offset:2048
    buffer_load_dwordx4 v[204:207], v1, s[68:71], s7 offen offset:3072
    s_add_u32 s7, s7, 32768
    buffer_load_dwordx4 v[208:211], v1, s[68:71], s7 offen offset:0
    buffer_load_dwordx4 v[212:215], v1, s[68:71], s7 offen offset:1024
    buffer_load_dwordx4 v[216:219], v1, s[68:71], s7 offen offset:2048
    buffer_load_dwordx4 v[220:223], v1, s[68:71], s7 offen offset:3072
    s_add_u32 s7, s7, 32768
    buffer_load_dwordx4 v[224:227], v1, s[68:71], s7 offen offset:0
    buffer_load_dwordx4 v[228:231], v1, s[68:71], s7 offen offset:1024
    buffer_load_dwordx4 v[232:235], v1, s[68:71], s7 offen offset:2048
    buffer_load_dwordx4 v[236:239], v1, s[68:71], s7 offen offset:3072
    s_add_u32 s7, s7, 32768
    buffer_load_dwordx4 v[240:243], v1, s[68:71], s7 offen offset:0
    buffer_load_dwordx4 v[244:247], v1, s[68:71], s7 offen offset:1024
    buffer_load_dwordx4 v[248:251], v1, s[68:71], s7 offen offset:2048
    buffer_load_dwordx4 v[252:255], v1, s[68:71], s7 offen offset:3072
    s_setpc_b64 s[36:37]
L_MV:
    s_waitcnt vmcnt(16)
    s_mov_b32 s96, 0x05040100
    s_mov_b32 s97, 0x07060302
    s_nop 1
    v_perm_b32 v128, v196, v192, s96
    v_perm_b32 v132, v196, v192, s97
    v_perm_b32 v129, v197, v193, s96
    v_perm_b32 v133, v197, v193, s97
    v_perm_b32 v130, v198, v194, s96
    v_perm_b32 v134, v198, v194, s97
    v_perm_b32 v131, v199, v195, s96
    v_perm_b32 v135, v199, v195, s97
    v_perm_b32 v136, v204, v200, s96
    v_perm_b32 v140, v204, v200, s97
    v_perm_b32 v137, v205, v201, s96
    v_perm_b32 v141, v205, v201, s97
    v_perm_b32 v138, v206, v202, s96
    v_perm_b32 v142, v206, v202, s97
    v_perm_b32 v139, v207, v203, s96
    v_perm_b32 v143, v207, v203, s97
    v_perm_b32 v144, v212, v208, s96
    v_perm_b32 v148, v212, v208, s97
    v_perm_b32 v145, v213, v209, s96
    v_perm_b32 v149, v213, v209, s97
    v_perm_b32 v146, v214, v210, s96
    v_perm_b32 v150, v214, v210, s97
    v_perm_b32 v147, v215, v211, s96
    v_perm_b32 v151, v215, v211, s97
    v_perm_b32 v152, v220, v216, s96
    v_perm_b32 v156, v220, v216, s97
    v_perm_b32 v153, v221, v217, s96
    v_perm_b32 v157, v221, v217, s97
    v_perm_b32 v154, v222, v218, s96
    v_perm_b32 v158, v222, v218, s97
    v_perm_b32 v155, v223, v219, s96
    v_perm_b32 v159, v223, v219, s97
    v_perm_b32 v160, v228, v224, s96
    v_perm_b32 v164, v228, v224, s97
    v_perm_b32 v161, v229, v225, s96
    v_perm_b32 v165, v229, v225, s97
    v_perm_b32 v162, v230, v226, s96
    v_perm_b32 v166, v230, v226, s97
    v_perm_b32 v163, v231, v227, s96
    v_perm_b32 v167, v231, v227, s97
    v_perm_b32 v168, v236, v232, s96
    v_perm_b32 v172, v236, v232, s97
    v_perm_b32 v169, v237, v233, s96
    v_perm_b32 v173, v237, v233, s97
    v_perm_b32 v170, v238, v234, s96
    v_perm_b32 v174, v238, v234, s97
    v_perm_b32 v171, v239, v235, s96
    v_perm_b32 v175, v239, v235, s97
    v_perm_b32 v176, v244, v240, s96
    v_perm_b32 v180, v244, v240, s97
    v_perm_b32 v177, v245, v241, s96
    v_perm_b32 v181, v245, v241, s97
    v_perm_b32 v178, v246, v242, s96
    v_perm_b32 v182, v246, v242, s97
    v_perm_b32 v179, v247, v243, s96
    v_perm_b32 v183, v247, v243, s97
    v_perm_b32 v184, v252, v248, s96
    v_perm_b32 v188, v252, v248, s97
    v_perm_b32 v185, v253, v249, s96
    v_perm_b32 v189, v253, v249, s97
    v_perm_b32 v186, v254, v250, s96
    v_perm_b32 v190, v254, v250, s97
    v_perm_b32 v187, v255, v251, s96
    v_perm_b32 v191, v255, v251, s97
    s_setpc_b64 s[36:37]
L_O1:
    s_nop 3
    v_mov_b32 v52, v20
    v_mov_b32 v54, v52
    s_nop 1
    v_permlane32_swap_b32 v52, v54
    s_nop 1
    v_max_f32 v52, v52, v54
    v_mov_b32 v54, v52
    s_nop 1
    v_permlane16_swap_b32 v52, v54
    s_nop 1
    v_max_f32 v52, v52, v54
    v_sub_f32 v53, v20, v52
    v_mul_f32 v53, s8, v53
    v_exp_f32 v53, v53
    s_nop 0
    v_mul_f32 v21, v21, v53
    v_mul_f32 v12, v12, v53
    v_mul_f32 v13, v13, v53
    v_mul_f32 v14, v14, v53
    v_mul_f32 v15, v15, v53
    v_mul_f32 v16, v16, v53
    v_mul_f32 v17, v17, v53
    v_mul_f32 v18, v18, v53
    v_mul_f32 v19, v19, v53
    v_mov_b32 v54, v21
    s_nop 1
    v_permlane32_swap_b32 v21, v54
    s_nop 1
    v_add_f32 v21, v21, v54
    v_mov_b32 v54, v21
    s_nop 1
    v_permlane16_swap_b32 v21, v54
    s_nop 1
    v_add_f32 v21, v21, v54
    s_nop 1
    v_permlane32_swap_b32 v12, v16
    v_permlane32_swap_b32 v13, v17
    v_permlane32_swap_b32 v14, v18
    v_permlane32_swap_b32 v15, v19
    s_nop 1
    v_add_f32 v12, v12, v16
    v_add_f32 v13, v13, v17
    v_add_f32 v14, v14, v18
    v_add_f32 v15, v15, v19
    s_nop 1
    v_permlane16_swap_b32 v12, v14
    v_permlane16_swap_b32 v13, v15
    s_nop 1
    v_add_f32 v12, v12, v14
    v_add_f32 v13, v13, v15
    s_lshl_b32 s7, s12, 12
    v_lshrrev_b32 v55, 6, v0
    v_lshlrev_b32 v54, 9, v55
    v_and_b32 v56, 15, v0
    v_lshl_add_u32 v54, v56, 5, v54
    v_bfe_u32 v56, v0, 4, 2
    v_lshl_add_u32 v54, v56, 3, v54
    v_add_u32 v54, s7, v54
    ds_write_b64 v54, v[12:13] offset:8192
    s_lshl_b32 s7, s12, 6
    v_lshl_add_u32 v54, v55, 3, s7
    v_mov_b32 v53, v21
    ds_write_b64 v54, v[52:53] offset:16384
    s_setpc_b64 s[36:37]
L_O2:
    s_lshl_b32 s7, s12, 6
    v_mov_b32 v60, s7
    ds_read_b128 v[44:47], v60 offset:16384
    ds_read_b128 v[48:51], v60 offset:16400
    ds_read_b128 v[52:55], v60 offset:16416
    ds_read_b128 v[56:59], v60 offset:16432
    v_lshrrev_b32 v60, 6, v0
    v_lshlrev_b32 v60, 2, v60
    v_and_b32 v61, 3, v0
    v_add_u32 v60, v60, v61
    v_bfe_u32 v61, v0, 2, 2
    v_lshl_add_u32 v60, v61, 5, v60
    s_lshl_b32 s7, s12, 12
    v_lshl_add_u32 v60, v60, 2, s7
    ds_read_b32 v12, v60 offset:8192
    ds_read_b32 v13, v60 offset:8704
    ds_read_b32 v14, v60 offset:9216
    ds_read_b32 v15, v60 offset:9728
    ds_read_b32 v16, v60 offset:10240
    ds_read_b32 v17, v60 offset:10752
    ds_read_b32 v18, v60 offset:11264
    ds_read_b32 v19, v60 offset:11776
    s_waitcnt lgkmcnt(0)
    v_max3_f32 v20, v44, v46, v48
    v_max3_f32 v20, v20, v50, v52
    v_max3_f32 v20, v20, v54, v56
    v_max_f32 v20, v20, v58
    v_sub_f32 v44, v44, v20
    v_sub_f32 v46, v46, v20
    v_sub_f32 v48, v48, v20
    v_sub_f32 v50, v50, v20
    v_sub_f32 v52, v52, v20
    v_sub_f32 v54, v54, v20
    v_sub_f32 v56, v56, v20
    v_sub_f32 v58, v58, v20
    v_mul_f32 v44, s8, v44
    v_mul_f32 v46, s8, v46
    v_mul_f32 v48, s8, v48
    v_mul_f32 v50, s8, v50
    v_mul_f32 v52, s8, v52
    v_mul_f32 v54, s8, v54
    v_mul_f32 v56, s8, v56
    v_mul_f32 v58, s8, v58
    v_exp_f32 v44, v44
    v_exp_f32 v46, v46
    v_exp_f32 v48, v48
    v_exp_f32 v50, v50
    v_exp_f32 v52, v52
    v_exp_f32 v54, v54
    v_exp_f32 v56, v56
    v_exp_f32 v58, v58
    s_nop 0
    v_mul_f32 v21, v44, v45
    v_mul_f32 v61, v44, v12
    v_fmac_f32 v21, v46, v47
    v_fmac_f32 v61, v46, v13
    v_fmac_f32 v21, v48, v49
    v_fmac_f32 v61, v48, v14
    v_fmac_f32 v21, v50, v51
    v_fmac_f32 v61, v50, v15
    v_fmac_f32 v21, v52, v53
    v_fmac_f32 v61, v52, v16
    v_fmac_f32 v21, v54, v55
    v_fmac_f32 v61, v54, v17
    v_fmac_f32 v21, v56, v57
    v_fmac_f32 v61, v56, v18
    v_fmac_f32 v21, v58, v59
    v_fmac_f32 v61, v58, v19
    s_nop 1
    v_mov_b32_dpp v60, v61 quad_perm:[1,0,3,2] row_mask:0xf bank_mask:0xf
    v_cvt_pk_bf16_f32 v61, v61, v60
    s_nop 1
    v_readlane_b32 s80, v61, 0
    v_readlane_b32 s81, v61, 2
    v_readlane_b32 s82, v61, 4
    v_readlane_b32 s83, v61, 6
    v_readlane_b32 s84, v61, 8
    v_readlane_b32 s85, v61, 10
    v_readlane_b32 s86, v61, 12
    v_readlane_b32 s87, v61, 14
    s_lshl_b32 s7, s12, 8
    s_add_u32 s7, s7, s9
    s_lshl_b32 s7, s7, 3
    s_add_u32 s7, s7, 0x100000
    v_cmp_eq_u32 vcc, 0, v0
    s_and_saveexec_b64 s[100:101], vcc
    s_cbranch_execz L_O_noml
    buffer_store_dwordx2 v[20:21], v4, s[76:79], s7 offen
L_O_noml:
    s_mov_b64 exec, s[100:101]
    v_dot2_f32_bf16 v12, v128, s80, 0
    v_dot2_f32_bf16 v13, v132, s80, 0
    v_dot2_f32_bf16 v14, v129, s80, 0
    v_dot2_f32_bf16 v15, v133, s80, 0
    v_dot2_f32_bf16 v16, v130, s80, 0
    v_dot2_f32_bf16 v17, v134, s80, 0
    v_dot2_f32_bf16 v18, v131, s80, 0
    v_dot2_f32_bf16 v19, v135, s80, 0
    v_dot2c_f32_bf16 v12, s81, v136
    v_dot2c_f32_bf16 v13, s81, v140
    v_dot2c_f32_bf16 v14, s81, v137
    v_dot2c_f32_bf16 v15, s81, v141
    v_dot2c_f32_bf16 v16, s81, v138
    v_dot2c_f32_bf16 v17, s81, v142
    v_dot2c_f32_bf16 v18, s81, v139
    v_dot2c_f32_bf16 v19, s81, v143
    v_dot2c_f32_bf16 v12, s82, v144
    v_dot2c_f32_bf16 v13, s82, v148
    v_dot2c_f32_bf16 v14, s82, v145
    v_dot2c_f32_bf16 v15, s82, v149
    v_dot2c_f32_bf16 v16, s82, v146
    v_dot2c_f32_bf16 v17, s82, v150
    v_dot2c_f32_bf16 v18, s82, v147
    v_dot2c_f32_bf16 v19, s82, v151
    v_dot2c_f32_bf16 v12, s83, v152
    v_dot2c_f32_bf16 v13, s83, v156
    v_dot2c_f32_bf16 v14, s83, v153
    v_dot2c_f32_bf16 v15, s83, v157
    v_dot2c_f32_bf16 v16, s83, v154
    v_dot2c_f32_bf16 v17, s83, v158
    v_dot2c_f32_bf16 v18, s83, v155
    v_dot2c_f32_bf16 v19, s83, v159
    v_dot2c_f32_bf16 v12, s84, v160
    v_dot2c_f32_bf16 v13, s84, v164
    v_dot2c_f32_bf16 v14, s84, v161
    v_dot2c_f32_bf16 v15, s84, v165
    v_dot2c_f32_bf16 v16, s84, v162
    v_dot2c_f32_bf16 v17, s84, v166
    v_dot2c_f32_bf16 v18, s84, v163
    v_dot2c_f32_bf16 v19, s84, v167
    v_dot2c_f32_bf16 v12, s85, v168
    v_dot2c_f32_bf16 v13, s85, v172
    v_dot2c_f32_bf16 v14, s85, v169
    v_dot2c_f32_bf16 v15, s85, v173
    v_dot2c_f32_bf16 v16, s85, v170
    v_dot2c_f32_bf16 v17, s85, v174
    v_dot2c_f32_bf16 v18, s85, v171
    v_dot2c_f32_bf16 v19, s85, v175
    v_dot2c_f32_bf16 v12, s86, v176
    v_dot2c_f32_bf16 v13, s86, v180
    v_dot2c_f32_bf16 v14, s86, v177
    v_dot2c_f32_bf16 v15, s86, v181
    v_dot2c_f32_bf16 v16, s86, v178
    v_dot2c_f32_bf16 v17, s86, v182
    v_dot2c_f32_bf16 v18, s86, v179
    v_dot2c_f32_bf16 v19, s86, v183
    v_dot2c_f32_bf16 v12, s87, v184
    v_dot2c_f32_bf16 v13, s87, v188
    v_dot2c_f32_bf16 v14, s87, v185
    v_dot2c_f32_bf16 v15, s87, v189
    v_dot2c_f32_bf16 v16, s87, v186
    v_dot2c_f32_bf16 v17, s87, v190
    v_dot2c_f32_bf16 v18, s87, v187
    v_dot2c_f32_bf16 v19, s87, v191
    s_lshl_b32 s7, s12, 14
    v_lshl_add_u32 v60, v0, 5, s7
    s_nop 1
    ds_write_b128 v60, v[12:15] offset:20480
    ds_write_b128 v60, v[16:19] offset:20496
    s_setpc_b64 s[36:37]
L_main_fin:
L_main_end:
    s_endpgm
.globl attn_final_kernel
.p2align 8
.type attn_final_kernel,@function
attn_final_kernel:
    s_cmp_ge_u32 s2, 64
    s_cbranch_scc1 L_fin_end
    s_load_dwordx2 s[4:5], s[0:1], 80
    s_load_dwordx2 s[6:7], s[0:1], 96
    s_lshr_b32 s3, s2, 5
    s_and_b32 s16, s2, 31
    s_lshl_b32 s17, s3, 19
    s_lshl_b32 s18, s16, 6
    s_add_u32 s17, s17, s18
    s_lshl_b32 s19, s3, 11
    s_add_u32 s19, s19, 0x100000
    s_mov_b32 s20, 0x3e0293ee
    v_lshrrev_b32 v1, 2, v0
    v_and_b32 v2, 3, v0
    v_lshlrev_b32 v3, 13, v1
    v_lshl_add_u32 v3, v2, 4, v3
    v_add_u32 v4, 4096, v3
    v_lshlrev_b32 v5, 3, v0
    s_waitcnt lgkmcnt(0)
    s_mov_b32 s8, s6
    s_mov_b32 s9, s7
    s_mov_b32 s10, 0x200000
    s_mov_b32 s11, 0x00020000
    s_mov_b32 s12, s4
    s_mov_b32 s13, s5
    s_mov_b32 s14, 2048
    s_mov_b32 s15, 0x00020000
    buffer_load_dwordx2 v[6:7], v5, s[8:11], s19 offen
    buffer_load_dwordx4 v[8:11], v3, s[8:11], s17 offen
    buffer_load_dwordx4 v[12:15], v3, s[8:11], s17 offen offset:2048
    buffer_load_dwordx4 v[16:19], v4, s[8:11], s17 offen
    buffer_load_dwordx4 v[20:23], v4, s[8:11], s17 offen offset:2048
    s_waitcnt vmcnt(4)
    v_max_f32_dpp v24, v6, v6 quad_perm:[1,0,3,2] row_mask:0xf bank_mask:0xf
    s_nop 1
    v_max_f32_dpp v24, v24, v24 quad_perm:[2,3,0,1] row_mask:0xf bank_mask:0xf
    s_nop 1
    v_max_f32_dpp v24, v24, v24 row_half_mirror row_mask:0xf bank_mask:0xf
    v_sub_f32 v25, v6, v24
    v_mul_f32 v25, s20, v25
    v_exp_f32 v25, v25
    s_nop 0
    v_mul_f32 v26, v25, v7
    s_nop 1
    v_add_f32_dpp v26, v26, v26 quad_perm:[1,0,3,2] row_mask:0xf bank_mask:0xf
    s_nop 1
    v_add_f32_dpp v26, v26, v26 quad_perm:[2,3,0,1] row_mask:0xf bank_mask:0xf
    s_nop 1
    v_add_f32_dpp v26, v26, v26 row_half_mirror row_mask:0xf bank_mask:0xf
    v_rcp_f32 v26, v26
    s_nop 0
    v_mul_f32 v25, v25, v26
    v_lshlrev_b32 v27, 2, v0
    ds_write_b32 v27, v25
    s_waitcnt lgkmcnt(0)
    s_barrier
    v_lshlrev_b32 v27, 4, v1
    ds_read_b128 v[28:31], v27
    s_waitcnt vmcnt(0) lgkmcnt(0)
    v_mul_f32 v8, v28, v8
    v_mul_f32 v9, v28, v9
    v_mul_f32 v10, v28, v10
    v_mul_f32 v11, v28, v11
    v_fmac_f32 v8, v29, v12
    v_fmac_f32 v9, v29, v13
    v_fmac_f32 v10, v29, v14
    v_fmac_f32 v11, v29, v15
    v_fmac_f32 v8, v30, v16
    v_fmac_f32 v9, v30, v17
    v_fmac_f32 v10, v30, v18
    v_fmac_f32 v11, v30, v19
    v_fmac_f32 v8, v31, v20
    v_fmac_f32 v9, v31, v21
    v_fmac_f32 v10, v31, v22
    v_fmac_f32 v11, v31, v23
    s_nop 1
    v_add_f32_dpp v8, v8, v8 row_ror:4 row_mask:0xf bank_mask:0xf
    v_add_f32_dpp v9, v9, v9 row_ror:4 row_mask:0xf bank_mask:0xf
    v_add_f32_dpp v10, v10, v10 row_ror:4 row_mask:0xf bank_mask:0xf
    v_add_f32_dpp v11, v11, v11 row_ror:4 row_mask:0xf bank_mask:0xf
    v_add_f32_dpp v8, v8, v8 row_ror:8 row_mask:0xf bank_mask:0xf
    v_add_f32_dpp v9, v9, v9 row_ror:8 row_mask:0xf bank_mask:0xf
    v_add_f32_dpp v10, v10, v10 row_ror:8 row_mask:0xf bank_mask:0xf
    v_add_f32_dpp v11, v11, v11 row_ror:8 row_mask:0xf bank_mask:0xf
    s_nop 1
    v_permlane32_swap_b32 v8, v10
    v_permlane32_swap_b32 v9, v11
    s_nop 1
    v_add_f32 v8, v8, v10
    v_add_f32 v9, v9, v11
    s_nop 1
    v_permlane16_swap_b32 v8, v9
    s_nop 1
    v_add_f32 v8, v8, v9
    v_bfe_u32 v12, v0, 4, 2
    v_lshl_add_u32 v12, v2, 2, v12
    v_lshrrev_b32 v13, 6, v0
    v_lshl_add_u32 v13, v13, 4, v12
    v_lshlrev_b32 v13, 2, v13
    ds_write_b32 v13, v8 offset:1024
    s_waitcnt lgkmcnt(0)
    s_barrier
    v_cmp_gt_u32 vcc, 16, v0
    s_and_saveexec_b64 s[22:23], vcc
    s_cbranch_execz L_fin_end
    v_lshlrev_b32 v13, 2, v0
    ds_read_b32 v8, v13 offset:1024
    ds_read_b32 v9, v13 offset:1088
    ds_read_b32 v10, v13 offset:1152
    ds_read_b32 v11, v13 offset:1216
    s_lshl_b32 s17, s2, 5
    v_lshlrev_b32 v14, 1, v0
    s_waitcnt lgkmcnt(0)
    v_add_f32 v8, v8, v9
    v_add_f32 v10, v10, v11
    v_add_f32 v8, v8, v10
    v_cvt_pk_bf16_f32 v8, v8, 0
    buffer_store_short v8, v14, s[12:15], s17 offen
L_fin_end:
    s_endpgm
.section .rodata,"a"
.p2align 6
.amdhsa_kernel attn_main_kernel
  .amdhsa_next_free_vgpr 256
  .amdhsa_next_free_sgpr 102
  .amdhsa_accum_offset 256
  .amdhsa_group_segment_fixed_size 0
  .amdhsa_kernarg_size 104
  .amdhsa_user_sgpr_count 2
  .amdhsa_user_sgpr_kernarg_segment_ptr 1
  .amdhsa_system_sgpr_workgroup_id_x 1
.end_amdhsa_kernel
.p2align 6
.amdhsa_kernel attn_final_kernel
  .amdhsa_next_free_vgpr 32
  .amdhsa_next_free_sgpr 32
  .amdhsa_accum_offset 32
  .amdhsa_group_segment_fixed_size 0
  .amdhsa_kernarg_size 104
  .amdhsa_user_sgpr_count 2
  .amdhsa_user_sgpr_kernarg_segment_ptr 1
  .amdhsa_system_sgpr_workgroup_id_x 1
.end_amdhsa_kernel
```
